```python
import torch

def _softmax(x, axis=-1):
    return torch.softmax(x, dim=axis)
def _gelu(x):
    return torch.nn.functional.gelu(x, approximate="tanh")
def _silu(x):
    return torch.nn.functional.silu(x)
def _sigmoid(x):
    return torch.sigmoid(x)
def _layernorm(x, axis=-1, eps=1e-5):
    m = x.mean(dim=axis, keepdim=True)
    v = x.var(dim=axis, keepdim=True, unbiased=False)
    return (x - m) / torch.sqrt(v + eps)
def _scatter_add(tgt, idx, src, axis=0):
    return tgt.clone().index_add_(axis, idx, src)
def _segment_sum(src, seg, n):
    out = torch.zeros((n,) + src.shape[1:], dtype=src.dtype)
    return out.index_add_(0, seg, src)
def _pad(x, pw):
    flat = tuple(v for pair in reversed(pw) for v in pair)
    return torch.nn.functional.pad(x, flat)

kernel_name = 'parallel_sum__ssm_conv_s4__glu_gated_reglu__prompt'

def setup_inputs():

    _w = (lambda a: (lambda t: t.to(torch.bfloat16) if t.is_floating_point() else t)(torch.as_tensor(a)))
    def _A_setup():
        B, L, D, N = 1, 2048, 448, 256
        A_re = -(lambda _x: torch.exp(torch.as_tensor(_x)))((lambda *s: torch.randn(*s, dtype=torch.bfloat16) * 6.4)(D, N))
        A_im = torch.pi * (lambda *s: torch.randn(*s, dtype=torch.bfloat16) * 0.05)(D, N)
        B_re = (lambda *s: torch.randn(*s, dtype=torch.bfloat16) * 0.1)(D, N)
        B_im = (lambda *s: torch.randn(*s, dtype=torch.bfloat16) * 0.1)(D, N)
        C_re = (lambda *s: torch.randn(*s, dtype=torch.bfloat16) * 0.1)(D, N)
        C_im = (lambda *s: torch.randn(*s, dtype=torch.bfloat16) * 0.1)(D, N)
        log_dt = (lambda *s: torch.randn(*s, dtype=torch.bfloat16) * 0.05)(D) * 0.5 - 4.0
        Dskip = (lambda *s: torch.randn(*s, dtype=torch.bfloat16) * 0.05)(D)
        return {
            "u": _w((lambda *s: torch.randn(*s, dtype=torch.bfloat16) * 0.05)(B, L, D)),
            "A_re": _w(A_re),
            "A_im": _w(A_im),
            "B_re": _w(B_re),
            "B_im": _w(B_im),
            "C_re": _w(C_re),
            "C_im": _w(C_im),
            "log_dt": _w(log_dt),
            "Dskip": _w(Dskip),
        }
    _A_in = _A_setup()

    def _B_setup():
        B, S, D, F = 1, 2048, 448, 1792
        return {
            "x": _w((lambda *s: torch.randn(*s, dtype=torch.bfloat16) * 0.05)(B, S, D)),
            "W_gate": _w((lambda *s: torch.randn(*s, dtype=torch.bfloat16) * 0.4)(D, F) * (2.0 / D) ** 0.5),
            "W_up": _w((lambda *s: torch.randn(*s, dtype=torch.bfloat16) * 0.4)(D, F) * (2.0 / D) ** 0.5),
            "W_down": _w((lambda *s: torch.randn(*s, dtype=torch.bfloat16) * 0.4)(F, D) * (1.0 / F) ** 0.5),
        }
    _B_in = _B_setup()

    return {
        "A_u": _A_in["u"],
        "A_A_re": _A_in["A_re"],
        "A_A_im": _A_in["A_im"],
        "A_B_re": _A_in["B_re"],
        "A_B_im": _A_in["B_im"],
        "A_C_re": _A_in["C_re"],
        "A_C_im": _A_in["C_im"],
        "A_log_dt": _A_in["log_dt"],
        "A_Dskip": _A_in["Dskip"],
        "B_x": _B_in["x"],
        "B_W_gate": _B_in["W_gate"],
        "B_W_up": _B_in["W_up"],
        "B_W_down": _B_in["W_down"],
    }

def reference(A_u, A_A_re, A_A_im, A_B_re, A_B_im, A_C_re, A_C_im, A_log_dt, A_Dskip, B_x, B_W_gate, B_W_up, B_W_down):
    def _A_ref(u, A_re, A_im, B_re, B_im, C_re, C_im, log_dt, Dskip):
        Bsz, L, D = u.shape
        dt = torch.exp(log_dt)[:, None]
        A = A_re + 1j * A_im
        Bc = B_re + 1j * B_im
        Cc = C_re + 1j * C_im
        logdA = dt * A
        dB = dt * Bc
        l = (lambda x, dt: x.to(dt))(torch.arange(L), A_re.dtype)
        P = torch.exp(logdA[:, :, None] * l[None, None, :])
        K = torch.einsum("dn,dnl,dn->dl", Cc, P, dB).real
        L2 = 2 * L
        Kp = _pad(K, ((0, 0), (0, L)))
        up = (lambda x, *d: x.permute(*d))(u, 0, 2, 1)
        up = _pad(up, ((0, 0), (0, 0), (0, L)))
        Kf = (lambda x, axes=(-2,-1): torch.fft.rfft2(x.float(), dim=axes))(Kp[:, None, :], axes=(-2, -1))
        Uf = (lambda x, axes=(-2,-1): torch.fft.rfft2(x.float(), dim=axes))(up[:, :, None, :], axes=(-2, -1))
        Yf = Uf * Kf[None, :, :, :]
        y = (lambda x, s, axes=(-2,-1): torch.fft.irfft2(x, s=s, dim=axes).to(torch.bfloat16))(Yf, (1, L2), axes=(-2, -1))[:, :, 0, :L]
        y = (lambda x, *d: x.permute(*d))(y, 0, 2, 1) + u * Dskip[None, None, :]
        return y

    def _B_ref(x, W_gate, W_up, W_down):
        gate = torch.einsum("bsd,df->bsf", x, W_gate)
        up = torch.einsum("bsd,df->bsf", x, W_up)
        gate = gate * (lambda x, dt: x.to(dt))(gate > 0, gate.dtype)
        h = gate * up
        return torch.einsum("bsf,fd->bsd", h, W_down)

    x = A_u
    xn = _layernorm(x, axis=-1)
    return x + _A_ref(xn, A_A_re, A_A_im, A_B_re, A_B_im, A_C_re, A_C_im, A_log_dt, A_Dskip) + _B_ref(xn, B_W_gate, B_W_up, B_W_down)
```

```asm
; @launch grid=(256,1,1) block=(512,1,1) lds=163840
.amdgcn_target "amdgcn-amd-amdhsa--gfx950"
.text
.globl parallel_sum__ssm_conv_s4__glu_gated_reglu__prompt_kernel
.p2align 8
.type parallel_sum__ssm_conv_s4__glu_gated_reglu__prompt_kernel,@function
parallel_sum__ssm_conv_s4__glu_gated_reglu__prompt_kernel:
    s_cmp_ge_u32 s2, 256
    s_cbranch_scc1 L_end
    s_load_dwordx16 s[4:19], s[0:1], 0
    s_load_dwordx16 s[20:35], s[0:1], 64
    v_lshrrev_b32 v2, 6, v0
    v_and_b32 v1, 63, v0
    v_readfirstlane_b32 s3, v2
    s_and_b32 s64, s2, 7
    s_lshr_b32 s65, s2, 3
    s_and_b32 s53, s3, 3
    s_getpc_b64 s[76:77]
L_pc0:
    s_and_b32 s54, s65, 3
    s_lshl_b32 s54, s54, 3
    s_add_u32 s54, s54, s3
    s_lshl_b32 s54, s54, 10
    v_and_b32 v14, 7, v0
    v_lshl_add_u32 v14, v14, 7, s54
    v_min_u32 v14, L_code_end-L_pc0, v14
    v_mov_b32 v15, s77
    v_add_co_u32 v14, vcc, s76, v14
    s_nop 1
    v_addc_co_u32 v15, vcc, 0, v15, vcc
    s_mov_b64 exec, 0xff
    global_load_dword v199, v[14:15], off
    s_mov_b64 exec, -1
    s_cmp_ge_u32 s2, 224
    s_cbranch_scc1 L_aux
    s_and_b32 s54, s64, 3
    s_lshl_b32 s54, s54, 2
    s_and_b32 s55, s65, 3
    s_add_u32 s59, s54, s55
    s_lshr_b32 s56, s64, 2
    s_mul_i32 s60, s56, 7
    s_lshr_b32 s62, s65, 2
    s_add_u32 s60, s60, s62
    s_lshl_b32 s54, s54, 1
    s_lshl_b32 s56, s56, 2
    s_add_u32 s61, s54, s56
    s_add_u32 s61, s61, s55
    s_lshr_b32 s54, s53, 1
    s_and_b32 s80, s53, 1
    s_mul_i32 s57, s64, 28
    s_add_u32 s64, s57, s65
    s_lshl_b32 s79, s64, 1
    s_add_u32 s79, s79, s54
    s_mul_i32 s81, s54, 17408
    s_mul_i32 s82, s54, 5632
    s_add_u32 s82, s82, 34816
    s_lshl_b32 s56, s79, 9
    s_lshl_b32 s57, s80, 8
    s_add_u32 s56, s56, s57
    s_cmp_lt_u32 s3, 4
    s_cselect_b32 s57, 128, 0
    s_add_u32 s56, s56, s57
    v_lshl_add_u32 v14, v1, 1, s56
    s_lshl_b32 s57, s64, 2
    v_mov_b32 v2, 0
    v_mov_b32 v3, 0
    v_mov_b32 v4, 0
    v_mov_b32 v5, 0
    v_mov_b32 v6, 0
    v_mov_b32 v7, 0
    s_waitcnt lgkmcnt(0)
    s_load_dword s83, s[18:19], s57
    s_load_dword s84, s[20:21], s57
    global_load_short_d16_hi v2, v14, s[6:7]
    global_load_short_d16_hi v3, v14, s[8:9]
    global_load_short_d16_hi v4, v14, s[10:11]
    global_load_short_d16_hi v5, v14, s[12:13]
    global_load_short_d16_hi v6, v14, s[14:15]
    global_load_short_d16_hi v7, v14, s[16:17]
    s_add_u32 s63, s55, s60
    s_and_b32 s63, s63, 3
    s_lshl_b32 s63, s63, 1
    s_lshl_b32 s54, s59, 2
    s_add_u32 s54, s54, s53
    s_mul_i32 s71, s54, 28672
    s_lshl_b32 s54, s63, 7
    s_add_u32 s66, s71, s54
    s_mov_b32 s67, s63
    s_lshr_b32 s54, s53, 1
    s_mul_i32 s54, s54, 57344
    s_lshl_b32 s56, s60, 8
    s_add_u32 s54, s54, s56
    s_mul_i32 s56, s63, 229376
    s_add_u32 s68, s54, s56
    s_lshl_b32 s69, s63, 1
    s_lshl_b32 s70, s53, 12
    s_add_u32 s70, s70, 49152
    s_cmp_eq_u32 s80, 0
    s_cselect_b32 s24, s24, s26
    s_cselect_b32 s25, s25, s27
    s_mov_b32 s26, 1605632
    s_mov_b32 s27, 0x20000
    s_cmp_ge_u32 s3, 4
    s_cselect_b32 s0, 1, 0
    v_lshrrev_b32 v40, 3, v1
    v_and_b32 v41, 7, v1
    v_lshrrev_b32 v42, 4, v1
    v_xor_b32 v41, v41, v42
    v_mul_u32_u24 v40, 896, v40
    v_lshl_add_u32 v200, v41, 4, v40
    v_xor_b32 v41, 4, v41
    v_lshl_add_u32 v201, v41, 4, v40
    v_add_u32 v201, 6144, v201
    v_add_u32 v202, 12288, v200
    v_add_u32 v203, 12288, v201
    s_lshl_b32 s56, s80, 2
    v_or_b32 v43, s56, v42
    v_bfe_u32 v44, v1, 1, 3
    v_xor_b32 v43, v43, v44
    v_lshlrev_b32 v43, 5, v43
    v_and_b32 v44, 1, v1
    v_lshl_add_u32 v43, v44, 4, v43
    v_mul_u32_u24 v42, 3584, v42
    v_add_u32 v204, v42, v43
    v_add_u32 v205, 13312, v204
    v_add_u32 v206, 26624, v204
    v_add_u32 v207, 39936, v204
    s_mov_b32 s40, s4
    s_mov_b32 s41, s5
    s_mov_b32 s42, 1835008
    s_mov_b32 s43, 0x20000
    s_and_b32 s54, s2, 7
    s_mul_i32 s54, s54, 7
    s_lshr_b32 s54, s54, 2
    s_mul_i32 s63, s62, 2
    s_add_u32 s63, s63, s54
    s_cmp_ge_u32 s63, 14
    s_cselect_b32 s54, 14, 0
    s_sub_u32 s63, s63, s54
    s_cmp_eq_u32 s0, 0
    s_cbranch_scc1 L_rg_1
    s_add_u32 m0, s70, 32768
    s_nop 0
    buffer_load_dwordx4 v200, s[40:43], s66 offen offset:0 lds
    buffer_load_dwordx4 v201, s[40:43], s66 offen offset:1024 lds
    buffer_load_dwordx4 v202, s[40:43], s66 offen offset:2048 lds
    buffer_load_dwordx4 v203, s[40:43], s66 offen offset:3072 lds
    s_add_u32 s66, s66, 128
    s_add_u32 s67, s67, 1
    s_cmp_eq_u32 s67, 7
    s_cselect_b32 s66, s71, s66
    s_add_u32 s68, s68, 114688
    s_add_u32 s69, s69, 1
    s_cmp_eq_u32 s69, 14
    s_cselect_b32 s74, 1605632, 0
    s_sub_u32 s68, s68, s74
    s_add_u32 s68, s68, 114688
    s_add_u32 s69, s69, 1
    s_cmp_eq_u32 s69, 14
    s_cselect_b32 s74, 1605632, 0
    s_sub_u32 s68, s68, s74
    s_mul_i32 s85, s53, 8704
    s_mul_i32 s78, s53, 2816
    s_add_u32 s78, s78, 34816
    s_lshl_b32 s54, s53, 2
    s_add_u32 s54, s54, 46096
    v_lshlrev_b32 v10, 2, v1
    v_add_u32 v10, 46144, v10
    v_writelane_b32 v10, s54, 0
    s_branch L_rd_2
L_rg_1:
    s_add_u32 m0, s70, 49152
    s_nop 0
    buffer_load_dwordx4 v204, s[24:27], s68 offen offset:0 lds
    buffer_load_dwordx4 v205, s[24:27], s68 offen offset:1024 lds
    buffer_load_dwordx4 v206, s[24:27], s68 offen offset:2048 lds
    buffer_load_dwordx4 v207, s[24:27], s68 offen offset:3072 lds
    s_add_u32 s68, s68, 114688
    s_add_u32 s69, s69, 1
    s_cmp_eq_u32 s69, 14
    s_cselect_b32 s74, 1605632, 0
    s_sub_u32 s68, s68, s74
    s_mul_i32 s85, s53, 8704
    s_add_u32 s85, s85, 46592
    s_mul_i32 s78, s53, 2816
    s_add_u32 s78, s78, 34816
    s_lshl_b32 s54, s53, 2
    s_add_u32 s54, s54, 46080
    v_lshlrev_b32 v10, 2, v1
    v_add_u32 v10, 46144, v10
    v_writelane_b32 v10, s54, 0
    v_mov_b32 v12, 0
    ds_write_b32 v10, v12
    ds_write_b32 v10, v12 offset:16
L_rd_2:
    s_mov_b32 s36, s34
    s_mov_b32 s37, s35
    s_mov_b32 s38, 16777216
    s_mov_b32 s39, 0x20000
    s_mov_b32 s44, s28
    s_mov_b32 s45, s29
    s_mov_b32 s46, 1605632
    s_mov_b32 s47, 0x20000
    s_waitcnt lgkmcnt(0)
    s_lshr_b32 s54, s53, 1
    s_lshl_b32 s54, s54, 4
    s_lshr_b32 s83, s83, s54
    s_lshl_b32 s83, s83, 16
    s_lshr_b32 s84, s84, s54
    s_lshl_b32 s84, s84, 16
    s_and_b32 s54, s3, 5
    s_cmp_eq_u32 s54, 4
    s_cselect_b32 s84, s84, 0
    v_mov_b32 v8, s83
    v_mul_f32 v8, 0x3fb8aa3b, v8
    v_exp_f32 v8, v8
    v_mov_b32 v9, 0
    v_writelane_b32 v9, s84, 0
    v_cvt_pk_bf16_f32 v8, v8, v8
    v_lshlrev_b32 v8, 16, v8
    v_and_b32 v176, 31, v1
    v_mul_u32_u24 v176, 272, v176
    v_lshrrev_b32 v36, 5, v1
    v_lshl_add_u32 v176, v36, 4, v176
    v_add_u32 v176, s85, v176
    s_mov_b32 s54, s78
    v_and_b32 v177, 31, v1
    v_lshrrev_b32 v178, 5, v1
    v_lshlrev_b32 v179, 5, v177
    v_lshl_add_u32 v179, v178, 4, v179
    v_add_u32 v179, s54, v179
    v_cmp_gt_u32 vcc, 32, v1
    v_lshlrev_b32 v180, 4, v177
    v_add_u32 v180, 1024, v180
    v_lshlrev_b32 v181, 3, v177
    v_add_u32 v182, 1536, v181
    v_cndmask_b32 v182, v182, v180, vcc
    v_add_u32 v180, 8, v180
    v_add_u32 v181, 1792, v181
    v_cndmask_b32 v181, v181, v180, vcc
    v_add_u32 v182, s54, v182
    v_add_u32 v181, s54, v181
    v_lshlrev_b32 v180, 2, v177
    v_lshl_add_u32 v180, v178, 9, v180
    v_add_u32 v180, s54, v180
    v_lshrrev_b32 v40, 4, v1
    v_and_b32 v41, 1, v40
    v_lshrrev_b32 v42, 1, v40
    v_bfe_u32 v43, v1, 2, 2
    v_lshl_add_u32 v42, v42, 3, v43
    v_lshlrev_b32 v42, 8, v42
    v_lshl_add_u32 v42, v41, 12, v42
    v_lshl_add_u32 v43, v41, 2, v43
    v_lshl_add_u32 v42, v43, 5, v42
    v_and_b32 v43, 3, v1
    v_lshl_add_u32 v42, v43, 3, v42
    v_add_u32 v42, 49152, v42
    s_and_b32 s54, s53, 1
    s_lshl_b32 s54, s54, 7
    v_xor_b32 v184, s54, v42
    v_and_b32 v40, 31, v1
    v_bfe_u32 v41, v1, 1, 3
    v_lshrrev_b32 v42, 5, v1
    v_xor_b32 v41, v41, v42
    v_lshlrev_b32 v41, 4, v41
    v_lshl_add_u32 v41, v40, 7, v41
    s_lshr_b32 s54, s53, 1
    s_lshl_b32 s54, s54, 13
    s_add_u32 s54, s54, 49152
    v_add_u32 v185, s54, v41
    s_cmp_eq_u32 s0, 0
    s_cbranch_scc1 L_rg_3
    s_lshl_b32 s54, s80, 12
    s_add_u32 s54, s81, s54
    v_lshrrev_b32 v186, 5, v1
    v_bfe_u32 v187, v1, 2, 2
    v_lshl_add_u32 v186, v186, 2, v187
    v_lshlrev_b32 v186, 7, v186
    v_and_b32 v187, 2, v187
    v_lshl_add_u32 v186, v187, 5, v186
    v_bfe_u32 v187, v1, 4, 1
    v_lshl_add_u32 v186, v187, 5, v186
    v_and_b32 v187, 3, v1
    v_lshl_add_u32 v186, v187, 3, v186
    v_xor_b32 v187, 64, v186
    v_add_u32 v186, s54, v186
    v_add_u32 v187, s54, v187
    s_branch L_rd_4
L_rg_3:
    v_lshrrev_b32 v186, 3, v1
    v_bfe_u32 v187, v1, 4, 1
    v_lshlrev_b32 v187, 2, v187
    v_and_b32 v188, 7, v1
    v_xor_b32 v187, v187, v188
    v_mul_u32_u24 v186, 896, v186
    v_lshl_add_u32 v186, v187, 4, v186
    v_add_u32 v187, 6144, v186
    s_lshl_b32 s78, s80, 2
    s_lshr_b32 s54, s53, 1
    s_add_u32 s78, s78, s54
    s_mov_b32 s77, s63
    s_lshl_b32 s54, s77, 3
    s_add_u32 s54, s54, s78
    s_add_u32 s54, s54, 2
    s_mul_i32 s54, s54, 14336
    s_lshl_b32 s55, s62, 7
    s_add_u32 s76, s54, s55
    s_lshl_b32 s54, s80, 12
    s_add_u32 s66, s81, s54
L_rd_4:
    s_waitcnt vmcnt(4)
    s_lshl_b32 s54, s2, 3
    s_add_u32 s54, s54, s3
    s_mul_i32 s54, s54, 896
    v_lshlrev_b32 v14, 7, v1
    s_mov_b64 exec, 0x7f
    buffer_load_dword v199, v14, s[44:47], s54 offen
    s_mov_b64 exec, -1
    s_mov_b32 m0, s85
    v_mul_f32 v16, v8, v2
    v_mul_f32 v17, v8, v3
    v_mul_f32 v16, 0x3fb8aa3b, v16
    v_mul_f32 v17, 0.15915494, v17
    v_mul_f32 v26, 0x41000000, v16
    v_mul_f32 v27, 0x41000000, v17
    v_mul_f32 v30, 0x42000000, v16
    v_mul_f32 v31, 0x42000000, v17
    v_mul_f32 v34, 0x42800000, v16
    v_mul_f32 v35, 0x42800000, v17
    v_exp_f32 v26, v26
    v_fract_f32 v27, v27
    v_exp_f32 v30, v30
    v_fract_f32 v31, v31
    v_exp_f32 v34, v34
    v_fract_f32 v35, v35
    v_cos_f32 v28, v27
    v_sin_f32 v29, v27
    v_cos_f32 v32, v31
    v_sin_f32 v33, v31
    v_cos_f32 v36, v35
    v_sin_f32 v37, v35
    v_mul_f32 v28, v26, v28
    v_mul_f32 v29, v26, v29
    v_mul_f32 v32, v30, v32
    v_mul_f32 v33, v30, v33
    v_mul_f32 v36, v34, v36
    v_mul_f32 v37, v34, v37
    v_cvt_pk_f16_f32 v41, v28, -v29
    v_cvt_pk_f16_f32 v44, v32, -v33
    v_cvt_pk_f16_f32 v48, v36, -v37
    v_mov_b32 v40, 0x3c00
    v_pk_mul_f16 v42, v41, v41 op_sel:[0,0] op_sel_hi:[0,1]
    ds_write_addtid_b32 v40 offset:0
    v_pk_mul_f16 v56, v48, v48 op_sel:[0,0] op_sel_hi:[0,1]
    ds_write_addtid_b32 v41 offset:272
    v_pk_mul_f16 v45, v44, v41 op_sel:[0,0] op_sel_hi:[0,1]
    ds_write_addtid_b32 v44 offset:1088
    v_pk_mul_f16 v49, v41, v48 op_sel:[0,0] op_sel_hi:[0,1]
    ds_write_addtid_b32 v48 offset:2176
    v_pk_mul_f16 v52, v44, v48 op_sel:[0,0] op_sel_hi:[0,1]
    v_pk_fma_f16 v42, v41, v41, v42 op_sel:[1,1,0] op_sel_hi:[1,0,1] neg_lo:[0,1,0]
    v_pk_fma_f16 v56, v48, v48, v56 op_sel:[1,1,0] op_sel_hi:[1,0,1] neg_lo:[0,1,0]
    v_pk_fma_f16 v45, v44, v41, v45 op_sel:[1,1,0] op_sel_hi:[1,0,1] neg_lo:[0,1,0]
    v_pk_fma_f16 v49, v41, v48, v49 op_sel:[1,1,0] op_sel_hi:[1,0,1] neg_lo:[0,1,0]
    v_pk_fma_f16 v52, v44, v48, v52 op_sel:[1,1,0] op_sel_hi:[1,0,1] neg_lo:[0,1,0]
    v_pk_mul_f16 v43, v42, v41 op_sel:[0,0] op_sel_hi:[0,1]
    ds_write_addtid_b32 v42 offset:544
    v_pk_mul_f16 v64, v56, v48 op_sel:[0,0] op_sel_hi:[0,1]
    ds_write_addtid_b32 v56 offset:4352
    v_pk_mul_f16 v46, v44, v42 op_sel:[0,0] op_sel_hi:[0,1]
    ds_write_addtid_b32 v45 offset:1360
    v_pk_mul_f16 v50, v42, v48 op_sel:[0,0] op_sel_hi:[0,1]
    ds_write_addtid_b32 v49 offset:2448
    v_pk_mul_f16 v53, v45, v48 op_sel:[0,0] op_sel_hi:[0,1]
    ds_write_addtid_b32 v52 offset:3264
    v_pk_mul_f16 v57, v41, v56 op_sel:[0,0] op_sel_hi:[0,1]
    v_pk_mul_f16 v60, v44, v56 op_sel:[0,0] op_sel_hi:[0,1]
    v_pk_mul_f16 v58, v42, v56 op_sel:[0,0] op_sel_hi:[0,1]
    v_pk_mul_f16 v61, v45, v56 op_sel:[0,0] op_sel_hi:[0,1]
    v_pk_fma_f16 v43, v42, v41, v43 op_sel:[1,1,0] op_sel_hi:[1,0,1] neg_lo:[0,1,0]
    v_pk_fma_f16 v64, v56, v48, v64 op_sel:[1,1,0] op_sel_hi:[1,0,1] neg_lo:[0,1,0]
    v_pk_fma_f16 v46, v44, v42, v46 op_sel:[1,1,0] op_sel_hi:[1,0,1] neg_lo:[0,1,0]
    v_pk_fma_f16 v50, v42, v48, v50 op_sel:[1,1,0] op_sel_hi:[1,0,1] neg_lo:[0,1,0]
    v_pk_fma_f16 v53, v45, v48, v53 op_sel:[1,1,0] op_sel_hi:[1,0,1] neg_lo:[0,1,0]
    v_pk_fma_f16 v57, v41, v56, v57 op_sel:[1,1,0] op_sel_hi:[1,0,1] neg_lo:[0,1,0]
    v_pk_fma_f16 v60, v44, v56, v60 op_sel:[1,1,0] op_sel_hi:[1,0,1] neg_lo:[0,1,0]
    v_pk_fma_f16 v58, v42, v56, v58 op_sel:[1,1,0] op_sel_hi:[1,0,1] neg_lo:[0,1,0]
    v_pk_fma_f16 v61, v45, v56, v61 op_sel:[1,1,0] op_sel_hi:[1,0,1] neg_lo:[0,1,0]
    v_pk_mul_f16 v47, v44, v43 op_sel:[0,0] op_sel_hi:[0,1]
    ds_write_addtid_b32 v43 offset:816
    v_pk_mul_f16 v51, v43, v48 op_sel:[0,0] op_sel_hi:[0,1]
    ds_write_addtid_b32 v64 offset:6528
    v_pk_mul_f16 v54, v46, v48 op_sel:[0,0] op_sel_hi:[0,1]
    ds_write_addtid_b32 v46 offset:1632
    v_pk_mul_f16 v59, v43, v56 op_sel:[0,0] op_sel_hi:[0,1]
    ds_write_addtid_b32 v50 offset:2720
    v_pk_mul_f16 v62, v46, v56 op_sel:[0,0] op_sel_hi:[0,1]
    ds_write_addtid_b32 v53 offset:3536
    v_pk_mul_f16 v65, v41, v64 op_sel:[0,0] op_sel_hi:[0,1]
    ds_write_addtid_b32 v57 offset:4624
    v_pk_mul_f16 v66, v42, v64 op_sel:[0,0] op_sel_hi:[0,1]
    ds_write_addtid_b32 v60 offset:5440
    v_pk_mul_f16 v67, v43, v64 op_sel:[0,0] op_sel_hi:[0,1]
    ds_write_addtid_b32 v58 offset:4896
    v_pk_mul_f16 v68, v44, v64 op_sel:[0,0] op_sel_hi:[0,1]
    ds_write_addtid_b32 v61 offset:5712
    v_pk_mul_f16 v69, v45, v64 op_sel:[0,0] op_sel_hi:[0,1]
    v_pk_mul_f16 v70, v46, v64 op_sel:[0,0] op_sel_hi:[0,1]
    v_pk_fma_f16 v47, v44, v43, v47 op_sel:[1,1,0] op_sel_hi:[1,0,1] neg_lo:[0,1,0]
    v_pk_fma_f16 v51, v43, v48, v51 op_sel:[1,1,0] op_sel_hi:[1,0,1] neg_lo:[0,1,0]
    v_pk_fma_f16 v54, v46, v48, v54 op_sel:[1,1,0] op_sel_hi:[1,0,1] neg_lo:[0,1,0]
    v_pk_fma_f16 v59, v43, v56, v59 op_sel:[1,1,0] op_sel_hi:[1,0,1] neg_lo:[0,1,0]
    v_pk_fma_f16 v62, v46, v56, v62 op_sel:[1,1,0] op_sel_hi:[1,0,1] neg_lo:[0,1,0]
    v_pk_fma_f16 v65, v41, v64, v65 op_sel:[1,1,0] op_sel_hi:[1,0,1] neg_lo:[0,1,0]
    v_pk_fma_f16 v66, v42, v64, v66 op_sel:[1,1,0] op_sel_hi:[1,0,1] neg_lo:[0,1,0]
    v_pk_fma_f16 v67, v43, v64, v67 op_sel:[1,1,0] op_sel_hi:[1,0,1] neg_lo:[0,1,0]
    v_pk_fma_f16 v68, v44, v64, v68 op_sel:[1,1,0] op_sel_hi:[1,0,1] neg_lo:[0,1,0]
    v_pk_fma_f16 v69, v45, v64, v69 op_sel:[1,1,0] op_sel_hi:[1,0,1] neg_lo:[0,1,0]
    v_pk_fma_f16 v70, v46, v64, v70 op_sel:[1,1,0] op_sel_hi:[1,0,1] neg_lo:[0,1,0]
    v_pk_mul_f16 v55, v47, v48 op_sel:[0,0] op_sel_hi:[0,1]
    ds_write_addtid_b32 v47 offset:1904
    v_pk_mul_f16 v63, v47, v56 op_sel:[0,0] op_sel_hi:[0,1]
    ds_write_addtid_b32 v51 offset:2992
    v_pk_mul_f16 v71, v47, v64 op_sel:[0,0] op_sel_hi:[0,1]
    ds_write_addtid_b32 v54 offset:3808
    v_pk_fma_f16 v55, v47, v48, v55 op_sel:[1,1,0] op_sel_hi:[1,0,1] neg_lo:[0,1,0]
    ds_write_addtid_b32 v59 offset:5168
    v_pk_fma_f16 v63, v47, v56, v63 op_sel:[1,1,0] op_sel_hi:[1,0,1] neg_lo:[0,1,0]
    ds_write_addtid_b32 v62 offset:5984
    v_pk_fma_f16 v71, v47, v64, v71 op_sel:[1,1,0] op_sel_hi:[1,0,1] neg_lo:[0,1,0]
    ds_write_addtid_b32 v65 offset:6800
    ds_write_addtid_b32 v66 offset:7072
    ds_write_addtid_b32 v67 offset:7344
    ds_write_addtid_b32 v68 offset:7616
    ds_write_addtid_b32 v69 offset:7888
    ds_write_addtid_b32 v70 offset:8160
    ds_write_addtid_b32 v55 offset:4080
    ds_write_addtid_b32 v63 offset:6256
    ds_write_addtid_b32 v71 offset:8432
    ds_read_b128 v[96:99], v176 offset:0
    ds_read_b128 v[100:103], v176 offset:32
    ds_read_b128 v[104:107], v176 offset:64
    ds_read_b128 v[108:111], v176 offset:96
    ds_read_b128 v[112:115], v176 offset:128
    ds_read_b128 v[116:119], v176 offset:160
    ds_read_b128 v[120:123], v176 offset:192
    ds_read_b128 v[124:127], v176 offset:224
    v_mul_f32 v26, 0x3f800000, v16
    v_mul_f32 v27, 0x3f800000, v17
    v_mul_f32 v30, 0x43800000, v16
    v_mul_f32 v31, 0x43800000, v17
    v_mul_f32 v34, 0x44800000, v16
    v_mul_f32 v35, 0x44800000, v17
    v_exp_f32 v26, v26
    v_fract_f32 v27, v27
    v_exp_f32 v30, v30
    v_fract_f32 v31, v31
    v_exp_f32 v34, v34
    v_fract_f32 v35, v35
    v_cos_f32 v28, v27
    v_sin_f32 v29, v27
    v_cos_f32 v32, v31
    v_sin_f32 v33, v31
    v_cos_f32 v36, v35
    v_sin_f32 v37, v35
    v_mul_f32 v28, v26, v28
    v_mul_f32 v29, v26, v29
    v_mul_f32 v32, v30, v32
    v_mul_f32 v33, v30, v33
    v_mul_f32 v36, v34, v36
    v_mul_f32 v37, v34, v37
    v_cvt_pk_f16_f32 v18, v28, v29
    v_cvt_pk_f16_f32 v21, v32, v33
    v_cvt_pk_f16_f32 v23, v36, v37
    v_mul_f32 v4, v8, v4
    v_mul_f32 v5, v8, v5
    v_mul_f32 v24, v34, v34
    v_mul_f32 v26, v6, v4
    v_mul_f32 v27, v6, v5
    v_max_f32 v24, 1.0, v24
    v_fma_f32 v26, -v7, v5, v26
    v_fmac_f32 v27, v7, v4
    v_max_f32 v28, |v26|, |v27|
    v_mul_f32 v28, v28, v24
    v_pk_mul_f16 v19, v18, v18 op_sel:[0,0] op_sel_hi:[0,1]
    v_pk_fma_f16 v19, v18, v18, v19 op_sel:[1,1,0] op_sel_hi:[1,0,1] neg_lo:[0,1,0]
    v_max_f32_dpp v28, v28, v28 row_shr:1 row_mask:0xf bank_mask:0xf
    v_pk_mul_f16 v22, v21, v21 op_sel:[0,0] op_sel_hi:[0,1]
    v_pk_fma_f16 v22, v21, v21, v22 op_sel:[1,1,0] op_sel_hi:[1,0,1] neg_lo:[0,1,0]
    v_max_f32_dpp v28, v28, v28 row_shr:2 row_mask:0xf bank_mask:0xf
    v_pk_mul_f16 v20, v19, v19 op_sel:[0,0] op_sel_hi:[0,1]
    v_pk_fma_f16 v20, v19, v19, v20 op_sel:[1,1,0] op_sel_hi:[1,0,1] neg_lo:[0,1,0]
    v_max_f32_dpp v28, v28, v28 row_shr:4 row_mask:0xf bank_mask:0xf
    s_nop 1
    v_max_f32_dpp v28, v28, v28 row_shr:8 row_mask:0xf bank_mask:0xf
    s_nop 1
    v_max_f32_dpp v28, v28, v28 row_bcast:15 row_mask:0xa bank_mask:0xf
    s_nop 1
    v_max_f32_dpp v28, v28, v28 row_bcast:31 row_mask:0xc bank_mask:0xf
    s_nop 0
    v_readlane_b32 s54, v28, 63
    s_nop 0
    s_and_b32 s54, s54, 0x7f800000
    s_min_u32 s54, s54, 0x7e000000
    s_max_u32 s75, s54, 0x01000000
    s_sub_u32 s54, 0x7f000000, s75
    v_mul_f32 v26, s54, v26
    v_mul_f32 v27, s54, v27
    v_cvt_pk_f16_f32 v72, v26, v27
    v_pk_mul_f16 v73, v72, v18 op_sel:[0,0] op_sel_hi:[0,1]
    ds_write_addtid_b32 v72 offset:0
    v_pk_mul_f16 v74, v72, v19 op_sel:[0,0] op_sel_hi:[0,1]
    v_pk_mul_f16 v76, v72, v20 op_sel:[0,0] op_sel_hi:[0,1]
    v_pk_mul_f16 v88, v72, v23 op_sel:[0,0] op_sel_hi:[0,1]
    v_pk_mul_f16 v80, v72, v21 op_sel:[0,0] op_sel_hi:[0,1]
    v_pk_mul_f16 v84, v72, v22 op_sel:[0,0] op_sel_hi:[0,1]
    v_pk_fma_f16 v73, v72, v18, v73 op_sel:[1,1,0] op_sel_hi:[1,0,1] neg_lo:[0,1,0]
    v_pk_fma_f16 v74, v72, v19, v74 op_sel:[1,1,0] op_sel_hi:[1,0,1] neg_lo:[0,1,0]
    v_pk_fma_f16 v76, v72, v20, v76 op_sel:[1,1,0] op_sel_hi:[1,0,1] neg_lo:[0,1,0]
    v_pk_fma_f16 v88, v72, v23, v88 op_sel:[1,1,0] op_sel_hi:[1,0,1] neg_lo:[0,1,0]
    v_pk_fma_f16 v80, v72, v21, v80 op_sel:[1,1,0] op_sel_hi:[1,0,1] neg_lo:[0,1,0]
    v_pk_fma_f16 v84, v72, v22, v84 op_sel:[1,1,0] op_sel_hi:[1,0,1] neg_lo:[0,1,0]
    v_pk_mul_f16 v75, v73, v19 op_sel:[0,0] op_sel_hi:[0,1]
    ds_write_addtid_b32 v73 offset:272
    v_pk_mul_f16 v77, v73, v20 op_sel:[0,0] op_sel_hi:[0,1]
    ds_write_addtid_b32 v74 offset:544
    v_pk_mul_f16 v78, v74, v20 op_sel:[0,0] op_sel_hi:[0,1]
    ds_write_addtid_b32 v76 offset:1088
    v_pk_mul_f16 v81, v74, v21 op_sel:[0,0] op_sel_hi:[0,1]
    ds_write_addtid_b32 v88 offset:4352
    v_pk_mul_f16 v82, v76, v21 op_sel:[0,0] op_sel_hi:[0,1]
    ds_write_addtid_b32 v80 offset:2176
    v_pk_mul_f16 v85, v76, v22 op_sel:[0,0] op_sel_hi:[0,1]
    ds_write_addtid_b32 v84 offset:3264
    v_pk_mul_f16 v89, v88, v21 op_sel:[0,0] op_sel_hi:[0,1]
    v_pk_mul_f16 v90, v88, v22 op_sel:[0,0] op_sel_hi:[0,1]
    v_pk_mul_f16 v92, v88, v23 op_sel:[0,0] op_sel_hi:[0,1]
    v_pk_mul_f16 v86, v84, v21 op_sel:[0,0] op_sel_hi:[0,1]
    v_pk_fma_f16 v75, v73, v19, v75 op_sel:[1,1,0] op_sel_hi:[1,0,1] neg_lo:[0,1,0]
    v_pk_fma_f16 v77, v73, v20, v77 op_sel:[1,1,0] op_sel_hi:[1,0,1] neg_lo:[0,1,0]
    v_pk_fma_f16 v78, v74, v20, v78 op_sel:[1,1,0] op_sel_hi:[1,0,1] neg_lo:[0,1,0]
    v_pk_fma_f16 v81, v74, v21, v81 op_sel:[1,1,0] op_sel_hi:[1,0,1] neg_lo:[0,1,0]
    v_pk_fma_f16 v82, v76, v21, v82 op_sel:[1,1,0] op_sel_hi:[1,0,1] neg_lo:[0,1,0]
    v_pk_fma_f16 v85, v76, v22, v85 op_sel:[1,1,0] op_sel_hi:[1,0,1] neg_lo:[0,1,0]
    v_pk_fma_f16 v89, v88, v21, v89 op_sel:[1,1,0] op_sel_hi:[1,0,1] neg_lo:[0,1,0]
    v_pk_fma_f16 v90, v88, v22, v90 op_sel:[1,1,0] op_sel_hi:[1,0,1] neg_lo:[0,1,0]
    v_pk_fma_f16 v92, v88, v23, v92 op_sel:[1,1,0] op_sel_hi:[1,0,1] neg_lo:[0,1,0]
    v_pk_fma_f16 v86, v84, v21, v86 op_sel:[1,1,0] op_sel_hi:[1,0,1] neg_lo:[0,1,0]
    v_pk_mul_f16 v79, v75, v20 op_sel:[0,0] op_sel_hi:[0,1]
    ds_write_addtid_b32 v75 offset:816
    v_pk_mul_f16 v83, v78, v21 op_sel:[0,0] op_sel_hi:[0,1]
    ds_write_addtid_b32 v77 offset:1360
    v_pk_mul_f16 v87, v85, v21 op_sel:[0,0] op_sel_hi:[0,1]
    ds_write_addtid_b32 v78 offset:1632
    v_pk_mul_f16 v91, v90, v21 op_sel:[0,0] op_sel_hi:[0,1]
    ds_write_addtid_b32 v81 offset:2448
    v_pk_fma_f16 v79, v75, v20, v79 op_sel:[1,1,0] op_sel_hi:[1,0,1] neg_lo:[0,1,0]
    ds_write_addtid_b32 v82 offset:2720
    v_pk_fma_f16 v83, v78, v21, v83 op_sel:[1,1,0] op_sel_hi:[1,0,1] neg_lo:[0,1,0]
    ds_write_addtid_b32 v85 offset:3536
    v_pk_fma_f16 v87, v85, v21, v87 op_sel:[1,1,0] op_sel_hi:[1,0,1] neg_lo:[0,1,0]
    ds_write_addtid_b32 v89 offset:4624
    v_pk_fma_f16 v91, v90, v21, v91 op_sel:[1,1,0] op_sel_hi:[1,0,1] neg_lo:[0,1,0]
    ds_write_addtid_b32 v90 offset:4896
    ds_write_addtid_b32 v92 offset:5440
    ds_write_addtid_b32 v86 offset:3808
    ds_write_addtid_b32 v79 offset:1904
    ds_write_addtid_b32 v83 offset:2992
    ds_write_addtid_b32 v87 offset:4080
    ds_write_addtid_b32 v91 offset:5168
    ds_read_b128 v[128:131], v176 offset:0
    ds_read_b128 v[132:135], v176 offset:32
    ds_read_b128 v[136:139], v176 offset:64
    ds_read_b128 v[140:143], v176 offset:96
    ds_read_b128 v[144:147], v176 offset:128
    ds_read_b128 v[148:151], v176 offset:160
    ds_read_b128 v[152:155], v176 offset:192
    ds_read_b128 v[156:159], v176 offset:224
    s_cmp_eq_u32 s0, 0
    s_cbranch_scc1 L_rg_5
    s_add_u32 m0, s70, 65536
    s_nop 0
    buffer_load_dwordx4 v200, s[40:43], s66 offen offset:0 lds
    buffer_load_dwordx4 v201, s[40:43], s66 offen offset:1024 lds
    buffer_load_dwordx4 v202, s[40:43], s66 offen offset:2048 lds
    buffer_load_dwordx4 v203, s[40:43], s66 offen offset:3072 lds
    s_add_u32 s66, s66, 128
    s_add_u32 s67, s67, 1
    s_cmp_eq_u32 s67, 7
    s_cselect_b32 s66, s71, s66
    s_branch L_rd_6
L_rg_5:
    s_add_u32 m0, s70, 81920
    s_nop 0
    buffer_load_dwordx4 v204, s[24:27], s68 offen offset:0 lds
    buffer_load_dwordx4 v205, s[24:27], s68 offen offset:1024 lds
    buffer_load_dwordx4 v206, s[24:27], s68 offen offset:2048 lds
    buffer_load_dwordx4 v207, s[24:27], s68 offen offset:3072 lds
L_rd_6:
    s_mov_b32 m0, s85
    s_cmp_eq_u32 s0, 0
    s_cbranch_scc1 L_nc_7
    s_add_u32 m0, s70, 98304
    s_nop 0
    buffer_load_dwordx4 v204, s[24:27], s68 offen offset:0 lds
    buffer_load_dwordx4 v205, s[24:27], s68 offen offset:1024 lds
    buffer_load_dwordx4 v206, s[24:27], s68 offen offset:2048 lds
    buffer_load_dwordx4 v207, s[24:27], s68 offen offset:3072 lds
    s_add_u32 s68, s68, 114688
    s_add_u32 s69, s69, 1
    s_cmp_eq_u32 s69, 14
    s_cselect_b32 s74, 1605632, 0
    s_sub_u32 s68, s68, s74
    s_mov_b32 m0, s85
L_nc_7:
    s_waitcnt lgkmcnt(7)
    v_mfma_f32_32x32x16_f16 v[160:175], v[128:131], v[96:99], 0
    v_xor_b32 v16, 0, v184
    v_add_u32 v20, 0x10000, v16
    v_mov_b32 v36, v186
    s_waitcnt lgkmcnt(6)
    v_mfma_f32_32x32x16_f16 v[160:175], v[132:135], v[100:103], v[160:175]
    v_xor_b32 v17, 32, v184
    v_add_u32 v21, 0x10000, v17
    v_mov_b32 v37, v187
    s_waitcnt lgkmcnt(5)
    v_mfma_f32_32x32x16_f16 v[160:175], v[136:139], v[104:107], v[160:175]
    v_xor_b32 v18, 64, v184
    v_add_u32 v22, 0x10000, v18
    s_waitcnt lgkmcnt(4)
    v_mfma_f32_32x32x16_f16 v[160:175], v[140:143], v[108:111], v[160:175]
    v_xor_b32 v19, 96, v184
    v_add_u32 v23, 0x10000, v19
    s_waitcnt lgkmcnt(3)
    v_mfma_f32_32x32x16_f16 v[160:175], v[144:147], v[112:115], v[160:175]
    v_xor_b32 v24, 0, v185
    v_add_u32 v28, 0x10000, v24
    s_waitcnt lgkmcnt(2)
    v_mfma_f32_32x32x16_f16 v[160:175], v[148:151], v[116:119], v[160:175]
    v_xor_b32 v25, 32, v185
    v_add_u32 v29, 0x10000, v25
    s_waitcnt lgkmcnt(1)
    v_mfma_f32_32x32x16_f16 v[160:175], v[152:155], v[120:123], v[160:175]
    v_xor_b32 v26, 64, v185
    v_add_u32 v30, 0x10000, v26
    s_waitcnt lgkmcnt(0)
    v_mfma_f32_32x32x16_f16 v[160:175], v[156:159], v[124:127], v[160:175]
    v_xor_b32 v27, 96, v185
    v_add_u32 v31, 0x10000, v27
    s_nop 9
    v_mul_f32 v160, s75, v160
    v_mul_f32 v161, s75, v161
    v_mul_f32 v162, s75, v162
    v_mul_f32 v163, s75, v163
    v_mul_f32 v164, s75, v164
    v_mul_f32 v165, s75, v165
    v_mul_f32 v166, s75, v166
    v_mul_f32 v167, s75, v167
    v_mul_f32 v168, s75, v168
    v_mul_f32 v169, s75, v169
    v_mul_f32 v170, s75, v170
    v_mul_f32 v171, s75, v171
    v_add_f32 v160, v160, v9
    s_cmp_eq_u32 s0, 0
    s_cbranch_scc1 L_rg_8
    s_waitcnt vmcnt(4)
    s_branch L_rd_9
L_rg_8:
    ds_write_b128 v179, v[160:163]
    ds_write_b64 v182, v[164:165]
    ds_write_b64 v181, v[166:167]
    ds_write_b32 v180, v168 offset:2048
    s_mov_b32 exec_hi, 0
    ds_write_b32 v180, v169 offset:2176
    ds_write_b32 v180, v170 offset:2304
    ds_write_b32 v180, v171 offset:2432
    s_mov_b64 exec, -1
    s_waitcnt vmcnt(0) lgkmcnt(0)
L_rd_9:
    s_barrier
    s_cmp_eq_u32 s0, 1
    s_cbranch_scc1 L_S
    s_setprio 2
    ds_read_b128 v[72:75], v24 offset:32768
    ds_read_b128 v[76:79], v24 offset:36864
    ds_read_b64_tr_b16 v[40:41], v16 offset:49152
    ds_read_b64_tr_b16 v[42:43], v16 offset:50176
    ds_read_b64_tr_b16 v[44:45], v17 offset:49152
    ds_read_b64_tr_b16 v[46:47], v17 offset:50176
    ds_read_b64_tr_b16 v[48:49], v18 offset:49152
    ds_read_b64_tr_b16 v[50:51], v18 offset:50176
    ds_read_b64_tr_b16 v[52:53], v19 offset:49152
    ds_read_b64_tr_b16 v[54:55], v19 offset:50176
    s_waitcnt lgkmcnt(6)
    v_mfma_f32_32x32x16_bf16 v[128:143], v[40:43], v[72:75], 0
    ds_read_b64_tr_b16 v[56:57], v16 offset:57344
    ds_read_b128 v[80:83], v25 offset:32768
    ds_read_b128 v[84:87], v25 offset:36864
    v_mfma_f32_32x32x16_bf16 v[144:159], v[40:43], v[76:79], 0
    ds_read_b64_tr_b16 v[58:59], v16 offset:58368
    ds_read_b128 v[88:91], v26 offset:32768
    ds_read_b128 v[92:95], v26 offset:36864
    s_waitcnt lgkmcnt(10)
    v_mfma_f32_32x32x16_bf16 v[160:175], v[44:47], v[72:75], 0
    ds_read_b64_tr_b16 v[60:61], v17 offset:57344
    ds_read_b128 v[96:99], v27 offset:32768
    ds_read_b128 v[100:103], v27 offset:36864
    v_mfma_f32_32x32x16_bf16 v[176:191], v[44:47], v[76:79], 0
    ds_read_b64_tr_b16 v[62:63], v17 offset:58368
    s_waitcnt lgkmcnt(12)
    v_mfma_f32_32x32x16_bf16 v[192:207], v[48:51], v[72:75], 0
    ds_read_b64_tr_b16 v[64:65], v18 offset:57344
    s_add_u32 m0, s66, 0
    s_nop 0
    buffer_load_dwordx4 v36, s[44:47], s76 offen lds
    buffer_load_dwordx4 v37, s[44:47], s76 offen offset:1024 lds
    s_add_u32 s76, s76, 114688
    s_add_u32 s77, s77, 1
    s_cmp_eq_u32 s77, 14
    s_cselect_b32 s74, 1605632, 0
    s_sub_u32 s76, s76, s74
    v_mfma_f32_32x32x16_bf16 v[208:223], v[48:51], v[76:79], 0
    ds_read_b64_tr_b16 v[66:67], v18 offset:58368
    s_waitcnt lgkmcnt(12)
    v_mfma_f32_32x32x16_bf16 v[224:239], v[52:55], v[72:75], 0
    ds_read_b64_tr_b16 v[68:69], v19 offset:57344
    v_mfma_f32_32x32x16_bf16 v[240:255], v[52:55], v[76:79], 0
    ds_read_b64_tr_b16 v[70:71], v19 offset:58368
    s_add_u32 m0, s66, 10752
    s_nop 0
    buffer_load_dwordx4 v36, s[44:47], s76 offen lds
    buffer_load_dwordx4 v37, s[44:47], s76 offen offset:1024 lds
    s_add_u32 s76, s76, 114688
    s_add_u32 s77, s77, 1
    s_cmp_eq_u32 s77, 14
    s_cselect_b32 s74, 1605632, 0
    s_sub_u32 s76, s76, s74
    s_waitcnt lgkmcnt(10)
    v_mfma_f32_32x32x16_bf16 v[128:143], v[56:59], v[80:83], v[128:143]
    s_waitcnt vmcnt(4)
    ds_read_b64_tr_b16 v[40:41], v20 offset:16384
    v_lshlrev_b32 v15, 4, v1
    v_mfma_f32_32x32x16_bf16 v[144:159], v[56:59], v[84:87], v[144:159]
    ds_read_b64_tr_b16 v[42:43], v20 offset:17408
    s_add_u32 m0, s66, 2048
    s_nop 0
    buffer_load_dwordx4 v36, s[44:47], s76 offen lds
    buffer_load_dwordx4 v37, s[44:47], s76 offen offset:1024 lds
    s_add_u32 s76, s76, 114688
    s_add_u32 s77, s77, 1
    s_cmp_eq_u32 s77, 14
    s_cselect_b32 s74, 1605632, 0
    s_sub_u32 s76, s76, s74
    s_lshl_b32 s55, s60, 1
    s_waitcnt lgkmcnt(6)
    v_mfma_f32_32x32x16_bf16 v[160:175], v[60:63], v[80:83], v[160:175]
    ds_read_b64_tr_b16 v[44:45], v21 offset:16384
    s_add_u32 s55, s55, s80
    s_lshl_b32 s54, s59, 1
    v_mfma_f32_32x32x16_bf16 v[176:191], v[60:63], v[84:87], v[176:191]
    ds_read_b64_tr_b16 v[46:47], v21 offset:17408
    s_lshr_b32 s57, s53, 1
    s_add_u32 s54, s54, s57
    s_waitcnt lgkmcnt(6)
    v_mfma_f32_32x32x16_bf16 v[192:207], v[64:67], v[80:83], v[192:207]
    ds_read_b64_tr_b16 v[48:49], v22 offset:16384
    s_lshl_b32 s56, s54, 5
    s_add_u32 s56, s56, s55
    v_mfma_f32_32x32x16_bf16 v[208:223], v[64:67], v[84:87], v[208:223]
    ds_read_b64_tr_b16 v[50:51], v22 offset:17408
    s_lshl_b32 s56, s56, 7
    s_add_u32 s83, s56, 14811136
    s_waitcnt lgkmcnt(6)
    v_mfma_f32_32x32x16_bf16 v[224:239], v[68:71], v[80:83], v[224:239]
    ds_read_b64_tr_b16 v[52:53], v23 offset:16384
    s_mul_i32 s56, s54, 56
    s_add_u32 s56, s56, s55
    v_mfma_f32_32x32x16_bf16 v[240:255], v[68:71], v[84:87], v[240:255]
    ds_read_b64_tr_b16 v[54:55], v23 offset:17408
    ds_read_b128 v[72:75], v28 offset:0
    ds_read_b128 v[76:79], v28 offset:4096
    s_waitcnt lgkmcnt(8)
    v_mfma_f32_32x32x16_bf16 v[128:143], v[40:43], v[88:91], v[128:143]
    ds_read_b64_tr_b16 v[56:57], v20 offset:24576
    ds_read_b128 v[80:83], v29 offset:0
    ds_read_b128 v[84:87], v29 offset:4096
    v_mfma_f32_32x32x16_bf16 v[144:159], v[40:43], v[92:95], v[144:159]
    ds_read_b64_tr_b16 v[58:59], v20 offset:25600
    s_lshl_b32 s56, s56, 12
    s_add_u32 s85, s56, 5242880
    s_waitcnt lgkmcnt(10)
    v_mfma_f32_32x32x16_bf16 v[160:175], v[44:47], v[88:91], v[160:175]
    ds_read_b64_tr_b16 v[60:61], v21 offset:24576
    s_add_u32 s84, s85, 114688
    s_lshl_b32 s68, s54, 9
    v_mfma_f32_32x32x16_bf16 v[176:191], v[44:47], v[92:95], v[176:191]
    ds_read_b64_tr_b16 v[62:63], v21 offset:25600
    s_add_u32 s68, s68, 32768
    s_lshl_b32 s69, s55, 10
    s_waitcnt lgkmcnt(10)
    v_mfma_f32_32x32x16_bf16 v[192:207], v[48:51], v[88:91], v[192:207]
    ds_read_b64_tr_b16 v[64:65], v22 offset:24576
    s_add_u32 s69, s69, 65536
    v_and_b32 v33, 31, v1
    v_mfma_f32_32x32x16_bf16 v[208:223], v[48:51], v[92:95], v[208:223]
    ds_read_b64_tr_b16 v[66:67], v22 offset:25600
    v_lshlrev_b32 v33, 3, v33
    v_lshrrev_b32 v38, 5, v1
    s_waitcnt lgkmcnt(10)
    v_mfma_f32_32x32x16_bf16 v[224:239], v[52:55], v[88:91], v[224:239]
    ds_read_b64_tr_b16 v[68:69], v23 offset:24576
    v_bfe_u32 v39, v1, 2, 2
    v_lshl_add_u32 v38, v38, 2, v39
    v_mfma_f32_32x32x16_bf16 v[240:255], v[52:55], v[92:95], v[240:255]
    ds_read_b64_tr_b16 v[70:71], v23 offset:25600
    ds_read_b128 v[88:91], v30 offset:0
    ds_read_b128 v[92:95], v30 offset:4096
    s_waitcnt lgkmcnt(8)
    v_mfma_f32_32x32x16_bf16 v[128:143], v[56:59], v[96:99], v[128:143]
    s_waitcnt vmcnt(2)
    s_barrier
    ds_read_b64_tr_b16 v[40:41], v20 offset:32768
    v_lshlrev_b32 v38, 7, v38
    v_mfma_f32_32x32x16_bf16 v[144:159], v[56:59], v[100:103], v[144:159]
    ds_read_b64_tr_b16 v[42:43], v20 offset:33792
    s_add_u32 m0, s66, 8704
    s_nop 0
    buffer_load_dwordx4 v36, s[44:47], s76 offen lds
    buffer_load_dwordx4 v37, s[44:47], s76 offen offset:1024 lds
    s_add_u32 s76, s76, 114688
    s_add_u32 s77, s77, 1
    s_cmp_eq_u32 s77, 14
    s_cselect_b32 s74, 1605632, 0
    s_sub_u32 s76, s76, s74
    v_and_b32 v39, 2, v39
    s_waitcnt lgkmcnt(8)
    v_mfma_f32_32x32x16_bf16 v[160:175], v[60:63], v[96:99], v[160:175]
    ds_read_b64_tr_b16 v[44:45], v21 offset:32768
    v_lshl_add_u32 v38, v39, 5, v38
    v_bfe_u32 v39, v1, 4, 1
    v_mfma_f32_32x32x16_bf16 v[176:191], v[60:63], v[100:103], v[176:191]
    ds_read_b64_tr_b16 v[46:47], v21 offset:33792
    v_lshl_add_u32 v38, v39, 5, v38
    v_and_b32 v39, 3, v1
    s_waitcnt lgkmcnt(8)
    v_mfma_f32_32x32x16_bf16 v[192:207], v[64:67], v[96:99], v[192:207]
    ds_read_b64_tr_b16 v[48:49], v22 offset:32768
    v_lshl_add_u32 v38, v39, 3, v38
    v_xor_b32 v39, 64, v38
    v_mfma_f32_32x32x16_bf16 v[208:223], v[64:67], v[100:103], v[208:223]
    ds_read_b64_tr_b16 v[50:51], v22 offset:33792
    v_add_u32 v38, s70, v38
    v_add_u32 v39, s70, v39
    s_waitcnt lgkmcnt(8)
    v_mfma_f32_32x32x16_bf16 v[224:239], v[68:71], v[96:99], v[224:239]
    ds_read_b64_tr_b16 v[52:53], v23 offset:32768
    v_add_u32 v34, 0x10000, v38
    v_add_u32 v35, 0x10000, v39
    v_mfma_f32_32x32x16_bf16 v[240:255], v[68:71], v[100:103], v[240:255]
    ds_read_b64_tr_b16 v[54:55], v23 offset:33792
    ds_read_b128 v[96:99], v31 offset:0
    ds_read_b128 v[100:103], v31 offset:4096
    s_waitcnt lgkmcnt(8)
    v_mfma_f32_32x32x16_bf16 v[128:143], v[40:43], v[72:75], v[128:143]
    ds_read_b64_tr_b16 v[56:57], v20 offset:40960
    v_mfma_f32_32x32x16_bf16 v[144:159], v[40:43], v[76:79], v[144:159]
    ds_read_b64_tr_b16 v[58:59], v20 offset:41984
    s_waitcnt lgkmcnt(8)
    v_mfma_f32_32x32x16_bf16 v[160:175], v[44:47], v[72:75], v[160:175]
    ds_read_b64_tr_b16 v[60:61], v21 offset:40960
    v_mfma_f32_32x32x16_bf16 v[176:191], v[44:47], v[76:79], v[176:191]
    ds_read_b64_tr_b16 v[62:63], v21 offset:41984
    s_waitcnt lgkmcnt(8)
    v_mfma_f32_32x32x16_bf16 v[192:207], v[48:51], v[72:75], v[192:207]
    ds_read_b64_tr_b16 v[64:65], v22 offset:40960
    v_mfma_f32_32x32x16_bf16 v[208:223], v[48:51], v[76:79], v[208:223]
    ds_read_b64_tr_b16 v[66:67], v22 offset:41984
    s_waitcnt lgkmcnt(8)
    v_mfma_f32_32x32x16_bf16 v[224:239], v[52:55], v[72:75], v[224:239]
    ds_read_b64_tr_b16 v[68:69], v23 offset:40960
    v_mfma_f32_32x32x16_bf16 v[240:255], v[52:55], v[76:79], v[240:255]
    ds_read_b64_tr_b16 v[70:71], v23 offset:41984
    s_waitcnt lgkmcnt(6)
    v_mfma_f32_32x32x16_bf16 v[128:143], v[56:59], v[80:83], v[128:143]
    s_waitcnt vmcnt(2)
    s_barrier
    ds_read_b64_tr_b16 v[40:41], v16 offset:16384
    v_mfma_f32_32x32x16_bf16 v[144:159], v[56:59], v[84:87], v[144:159]
    ds_read_b64_tr_b16 v[42:43], v16 offset:17408
    s_add_u32 m0, s66, 0
    s_nop 0
    buffer_load_dwordx4 v36, s[44:47], s76 offen lds
    buffer_load_dwordx4 v37, s[44:47], s76 offen offset:1024 lds
    s_add_u32 s76, s76, 114688
    s_add_u32 s77, s77, 1
    s_cmp_eq_u32 s77, 14
    s_cselect_b32 s74, 1605632, 0
    s_sub_u32 s76, s76, s74
    s_waitcnt lgkmcnt(6)
    v_mfma_f32_32x32x16_bf16 v[160:175], v[60:63], v[80:83], v[160:175]
    ds_read_b64_tr_b16 v[44:45], v17 offset:16384
    v_mfma_f32_32x32x16_bf16 v[176:191], v[60:63], v[84:87], v[176:191]
    ds_read_b64_tr_b16 v[46:47], v17 offset:17408
    s_waitcnt lgkmcnt(6)
    v_mfma_f32_32x32x16_bf16 v[192:207], v[64:67], v[80:83], v[192:207]
    ds_read_b64_tr_b16 v[48:49], v18 offset:16384
    s_add_u32 m0, s66, 10752
    s_nop 0
    buffer_load_dwordx4 v36, s[44:47], s76 offen lds
    buffer_load_dwordx4 v37, s[44:47], s76 offen offset:1024 lds
    s_add_u32 s76, s76, 114688
    s_add_u32 s77, s77, 1
    s_cmp_eq_u32 s77, 14
    s_cselect_b32 s74, 1605632, 0
    s_sub_u32 s76, s76, s74
    v_mfma_f32_32x32x16_bf16 v[208:223], v[64:67], v[84:87], v[208:223]
    ds_read_b64_tr_b16 v[50:51], v18 offset:17408
    s_waitcnt lgkmcnt(6)
    v_mfma_f32_32x32x16_bf16 v[224:239], v[68:71], v[80:83], v[224:239]
    ds_read_b64_tr_b16 v[52:53], v19 offset:16384
    v_mfma_f32_32x32x16_bf16 v[240:255], v[68:71], v[84:87], v[240:255]
    ds_read_b64_tr_b16 v[54:55], v19 offset:17408
    ds_read_b128 v[72:75], v24 offset:0
    ds_read_b128 v[76:79], v24 offset:4096
    s_waitcnt lgkmcnt(8)
    v_mfma_f32_32x32x16_bf16 v[128:143], v[40:43], v[88:91], v[128:143]
    ds_read_b64_tr_b16 v[56:57], v16 offset:24576
    ds_read_b128 v[80:83], v25 offset:0
    ds_read_b128 v[84:87], v25 offset:4096
    v_mfma_f32_32x32x16_bf16 v[144:159], v[40:43], v[92:95], v[144:159]
    ds_read_b64_tr_b16 v[58:59], v16 offset:25600
    s_waitcnt lgkmcnt(10)
    v_mfma_f32_32x32x16_bf16 v[160:175], v[44:47], v[88:91], v[160:175]
    ds_read_b64_tr_b16 v[60:61], v17 offset:24576
    v_mfma_f32_32x32x16_bf16 v[176:191], v[44:47], v[92:95], v[176:191]
    ds_read_b64_tr_b16 v[62:63], v17 offset:25600
    s_waitcnt lgkmcnt(10)
    v_mfma_f32_32x32x16_bf16 v[192:207], v[48:51], v[88:91], v[192:207]
    ds_read_b64_tr_b16 v[64:65], v18 offset:24576
    v_mfma_f32_32x32x16_bf16 v[208:223], v[48:51], v[92:95], v[208:223]
    ds_read_b64_tr_b16 v[66:67], v18 offset:25600
    s_waitcnt lgkmcnt(10)
    v_mfma_f32_32x32x16_bf16 v[224:239], v[52:55], v[88:91], v[224:239]
    ds_read_b64_tr_b16 v[68:69], v19 offset:24576
    v_mfma_f32_32x32x16_bf16 v[240:255], v[52:55], v[92:95], v[240:255]
    ds_read_b64_tr_b16 v[70:71], v19 offset:25600
    ds_read_b128 v[88:91], v26 offset:0
    ds_read_b128 v[92:95], v26 offset:4096
    s_waitcnt lgkmcnt(8)
    v_mfma_f32_32x32x16_bf16 v[128:143], v[56:59], v[96:99], v[128:143]
    s_waitcnt vmcnt(4)
    s_barrier
    ds_read_b64_tr_b16 v[40:41], v16 offset:49152
    v_mfma_f32_32x32x16_bf16 v[144:159], v[56:59], v[100:103], v[144:159]
    ds_read_b64_tr_b16 v[42:43], v16 offset:50176
    s_add_u32 m0, s66, 2048
    s_nop 0
    buffer_load_dwordx4 v36, s[44:47], s76 offen lds
    buffer_load_dwordx4 v37, s[44:47], s76 offen offset:1024 lds
    s_add_u32 s76, s76, 114688
    s_add_u32 s77, s77, 1
    s_cmp_eq_u32 s77, 14
    s_cselect_b32 s74, 1605632, 0
    s_sub_u32 s76, s76, s74
    s_waitcnt lgkmcnt(8)
    v_mfma_f32_32x32x16_bf16 v[160:175], v[60:63], v[96:99], v[160:175]
    ds_read_b64_tr_b16 v[44:45], v17 offset:49152
    v_mfma_f32_32x32x16_bf16 v[176:191], v[60:63], v[100:103], v[176:191]
    ds_read_b64_tr_b16 v[46:47], v17 offset:50176
    s_waitcnt lgkmcnt(8)
    v_mfma_f32_32x32x16_bf16 v[192:207], v[64:67], v[96:99], v[192:207]
    ds_read_b64_tr_b16 v[48:49], v18 offset:49152
    v_mfma_f32_32x32x16_bf16 v[208:223], v[64:67], v[100:103], v[208:223]
    ds_read_b64_tr_b16 v[50:51], v18 offset:50176
    s_waitcnt lgkmcnt(8)
    v_mfma_f32_32x32x16_bf16 v[224:239], v[68:71], v[96:99], v[224:239]
    ds_read_b64_tr_b16 v[52:53], v19 offset:49152
    v_mfma_f32_32x32x16_bf16 v[240:255], v[68:71], v[100:103], v[240:255]
    ds_read_b64_tr_b16 v[54:55], v19 offset:50176
    ds_read_b128 v[96:99], v27 offset:0
    ds_read_b128 v[100:103], v27 offset:4096
    s_waitcnt lgkmcnt(8)
    v_mfma_f32_32x32x16_bf16 v[128:143], v[40:43], v[72:75], v[128:143]
    ds_read_b64_tr_b16 v[56:57], v16 offset:57344
    v_mfma_f32_32x32x16_bf16 v[144:159], v[40:43], v[76:79], v[144:159]
    ds_read_b64_tr_b16 v[58:59], v16 offset:58368
    s_waitcnt lgkmcnt(8)
    v_mfma_f32_32x32x16_bf16 v[160:175], v[44:47], v[72:75], v[160:175]
    ds_read_b64_tr_b16 v[60:61], v17 offset:57344
    v_mfma_f32_32x32x16_bf16 v[176:191], v[44:47], v[76:79], v[176:191]
    ds_read_b64_tr_b16 v[62:63], v17 offset:58368
    s_waitcnt lgkmcnt(8)
    v_mfma_f32_32x32x16_bf16 v[192:207], v[48:51], v[72:75], v[192:207]
    ds_read_b64_tr_b16 v[64:65], v18 offset:57344
    v_mfma_f32_32x32x16_bf16 v[208:223], v[48:51], v[76:79], v[208:223]
    ds_read_b64_tr_b16 v[66:67], v18 offset:58368
    s_waitcnt lgkmcnt(8)
    v_mfma_f32_32x32x16_bf16 v[224:239], v[52:55], v[72:75], v[224:239]
    ds_read_b64_tr_b16 v[68:69], v19 offset:57344
    v_mfma_f32_32x32x16_bf16 v[240:255], v[52:55], v[76:79], v[240:255]
    ds_read_b64_tr_b16 v[70:71], v19 offset:58368
    s_waitcnt lgkmcnt(6)
    v_mfma_f32_32x32x16_bf16 v[128:143], v[56:59], v[80:83], v[128:143]
    s_waitcnt vmcnt(2)
    s_barrier
    ds_read_b64_tr_b16 v[40:41], v20 offset:16384
    v_mfma_f32_32x32x16_bf16 v[144:159], v[56:59], v[84:87], v[144:159]
    ds_read_b64_tr_b16 v[42:43], v20 offset:17408
    s_add_u32 m0, s66, 8704
    s_nop 0
    buffer_load_dwordx4 v36, s[44:47], s76 offen lds
    buffer_load_dwordx4 v37, s[44:47], s76 offen offset:1024 lds
    s_add_u32 s76, s76, 114688
    s_add_u32 s77, s77, 1
    s_cmp_eq_u32 s77, 14
    s_cselect_b32 s74, 1605632, 0
    s_sub_u32 s76, s76, s74
    s_waitcnt lgkmcnt(6)
    v_mfma_f32_32x32x16_bf16 v[160:175], v[60:63], v[80:83], v[160:175]
    ds_read_b64_tr_b16 v[44:45], v21 offset:16384
    v_mfma_f32_32x32x16_bf16 v[176:191], v[60:63], v[84:87], v[176:191]
    ds_read_b64_tr_b16 v[46:47], v21 offset:17408
    s_waitcnt lgkmcnt(6)
    v_mfma_f32_32x32x16_bf16 v[192:207], v[64:67], v[80:83], v[192:207]
    ds_read_b64_tr_b16 v[48:49], v22 offset:16384
    v_mfma_f32_32x32x16_bf16 v[208:223], v[64:67], v[84:87], v[208:223]
    ds_read_b64_tr_b16 v[50:51], v22 offset:17408
    s_waitcnt lgkmcnt(6)
    v_mfma_f32_32x32x16_bf16 v[224:239], v[68:71], v[80:83], v[224:239]
    ds_read_b64_tr_b16 v[52:53], v23 offset:16384
    v_mfma_f32_32x32x16_bf16 v[240:255], v[68:71], v[84:87], v[240:255]
    ds_read_b64_tr_b16 v[54:55], v23 offset:17408
    ds_read_b128 v[72:75], v24 offset:32768
    ds_read_b128 v[76:79], v24 offset:36864
    s_waitcnt lgkmcnt(8)
    v_mfma_f32_32x32x16_bf16 v[128:143], v[40:43], v[88:91], v[128:143]
    ds_read_b64_tr_b16 v[56:57], v20 offset:24576
    ds_read_b128 v[80:83], v25 offset:32768
    ds_read_b128 v[84:87], v25 offset:36864
    v_mfma_f32_32x32x16_bf16 v[144:159], v[40:43], v[92:95], v[144:159]
    ds_read_b64_tr_b16 v[58:59], v20 offset:25600
    s_load_dword s52, s[32:33], 0
    s_waitcnt lgkmcnt(10)
    v_mfma_f32_32x32x16_bf16 v[160:175], v[44:47], v[88:91], v[160:175]
    ds_read_b64_tr_b16 v[60:61], v21 offset:24576
    v_mfma_f32_32x32x16_bf16 v[176:191], v[44:47], v[92:95], v[176:191]
    ds_read_b64_tr_b16 v[62:63], v21 offset:25600
    s_waitcnt lgkmcnt(10)
    v_mfma_f32_32x32x16_bf16 v[192:207], v[48:51], v[88:91], v[192:207]
    ds_read_b64_tr_b16 v[64:65], v22 offset:24576
    v_mfma_f32_32x32x16_bf16 v[208:223], v[48:51], v[92:95], v[208:223]
    ds_read_b64_tr_b16 v[66:67], v22 offset:25600
    s_waitcnt lgkmcnt(10)
    v_mfma_f32_32x32x16_bf16 v[224:239], v[52:55], v[88:91], v[224:239]
    ds_read_b64_tr_b16 v[68:69], v23 offset:24576
    v_mfma_f32_32x32x16_bf16 v[240:255], v[52:55], v[92:95], v[240:255]
    ds_read_b64_tr_b16 v[70:71], v23 offset:25600
    ds_read_b128 v[88:91], v26 offset:32768
    ds_read_b128 v[92:95], v26 offset:36864
    s_waitcnt lgkmcnt(8)
    v_mfma_f32_32x32x16_bf16 v[128:143], v[56:59], v[96:99], v[128:143]
    s_waitcnt vmcnt(2)
    s_barrier
    ds_read_b64_tr_b16 v[40:41], v20 offset:32768
    v_mfma_f32_32x32x16_bf16 v[144:159], v[56:59], v[100:103], v[144:159]
    ds_read_b64_tr_b16 v[42:43], v20 offset:33792
    s_add_u32 m0, s66, 0
    s_nop 0
    buffer_load_dwordx4 v36, s[44:47], s76 offen lds
    buffer_load_dwordx4 v37, s[44:47], s76 offen offset:1024 lds
    s_add_u32 s76, s76, 114688
    s_add_u32 s77, s77, 1
    s_cmp_eq_u32 s77, 14
    s_cselect_b32 s74, 1605632, 0
    s_sub_u32 s76, s76, s74
    s_waitcnt lgkmcnt(8)
    v_mfma_f32_32x32x16_bf16 v[160:175], v[60:63], v[96:99], v[160:175]
    ds_read_b64_tr_b16 v[44:45], v21 offset:32768
    v_mfma_f32_32x32x16_bf16 v[176:191], v[60:63], v[100:103], v[176:191]
    ds_read_b64_tr_b16 v[46:47], v21 offset:33792
    s_waitcnt lgkmcnt(8)
    v_mfma_f32_32x32x16_bf16 v[192:207], v[64:67], v[96:99], v[192:207]
    ds_read_b64_tr_b16 v[48:49], v22 offset:32768
    s_add_u32 m0, s66, 10752
    s_nop 0
    buffer_load_dwordx4 v36, s[44:47], s76 offen lds
    buffer_load_dwordx4 v37, s[44:47], s76 offen offset:1024 lds
    s_add_u32 s76, s76, 114688
    s_add_u32 s77, s77, 1
    s_cmp_eq_u32 s77, 14
    s_cselect_b32 s74, 1605632, 0
    s_sub_u32 s76, s76, s74
    v_mfma_f32_32x32x16_bf16 v[208:223], v[64:67], v[100:103], v[208:223]
    ds_read_b64_tr_b16 v[50:51], v22 offset:33792
    s_waitcnt lgkmcnt(8)
    v_mfma_f32_32x32x16_bf16 v[224:239], v[68:71], v[96:99], v[224:239]
    ds_read_b64_tr_b16 v[52:53], v23 offset:32768
    v_mfma_f32_32x32x16_bf16 v[240:255], v[68:71], v[100:103], v[240:255]
    ds_read_b64_tr_b16 v[54:55], v23 offset:33792
    ds_read_b128 v[96:99], v27 offset:32768
    ds_read_b128 v[100:103], v27 offset:36864
    s_waitcnt lgkmcnt(8)
    v_mfma_f32_32x32x16_bf16 v[128:143], v[40:43], v[72:75], v[128:143]
    ds_read_b64_tr_b16 v[56:57], v20 offset:40960
    v_mfma_f32_32x32x16_bf16 v[144:159], v[40:43], v[76:79], v[144:159]
    ds_read_b64_tr_b16 v[58:59], v20 offset:41984
    s_waitcnt lgkmcnt(8)
    v_mfma_f32_32x32x16_bf16 v[160:175], v[44:47], v[72:75], v[160:175]
    ds_read_b64_tr_b16 v[60:61], v21 offset:40960
    v_mfma_f32_32x32x16_bf16 v[176:191], v[44:47], v[76:79], v[176:191]
    ds_read_b64_tr_b16 v[62:63], v21 offset:41984
    s_waitcnt lgkmcnt(8)
    v_mfma_f32_32x32x16_bf16 v[192:207], v[48:51], v[72:75], v[192:207]
    ds_read_b64_tr_b16 v[64:65], v22 offset:40960
    s_waitcnt lgkmcnt(0)
    s_cmp_eq_u32 s52, 0
    s_cbranch_scc1 L_nonce_10
L_ndone_11:
    v_mov_b32 v108, 0
    v_mfma_f32_32x32x16_bf16 v[208:223], v[48:51], v[76:79], v[208:223]
    ds_read_b64_tr_b16 v[66:67], v22 offset:41984
    v_mov_b32 v109, 0
    v_mov_b32 v112, 0
    v_mfma_f32_32x32x16_bf16 v[224:239], v[52:55], v[72:75], v[224:239]
    ds_read_b64_tr_b16 v[68:69], v23 offset:40960
    v_mov_b32 v113, 0
    v_mov_b32 v116, 0
    v_mfma_f32_32x32x16_bf16 v[240:255], v[52:55], v[76:79], v[240:255]
    ds_read_b64_tr_b16 v[70:71], v23 offset:41984
    v_mov_b32 v117, 0
    v_mov_b32 v120, 0
    v_mfma_f32_32x32x16_bf16 v[128:143], v[56:59], v[80:83], v[128:143]
    s_waitcnt vmcnt(4)
    s_barrier
    ds_read_b64_tr_b16 v[40:41], v16 offset:16384
    v_mov_b32 v121, 0
    v_mfma_f32_32x32x16_bf16 v[144:159], v[56:59], v[84:87], v[144:159]
    ds_read_b64_tr_b16 v[42:43], v16 offset:17408
    s_add_u32 m0, s66, 2048
    s_nop 0
    buffer_load_dwordx4 v36, s[44:47], s76 offen lds
    buffer_load_dwordx4 v37, s[44:47], s76 offen offset:1024 lds
    s_add_u32 s76, s76, 114688
    s_add_u32 s77, s77, 1
    s_cmp_eq_u32 s77, 14
    s_cselect_b32 s74, 1605632, 0
    s_sub_u32 s76, s76, s74
    v_mov_b32 v124, 0
    v_mfma_f32_32x32x16_bf16 v[160:175], v[60:63], v[80:83], v[160:175]
    ds_read_b64_tr_b16 v[44:45], v17 offset:16384
    v_mov_b32 v125, 0
    v_mfma_f32_32x32x16_bf16 v[176:191], v[60:63], v[84:87], v[176:191]
    ds_read_b64_tr_b16 v[46:47], v17 offset:17408
    s_waitcnt lgkmcnt(6)
    v_mfma_f32_32x32x16_bf16 v[192:207], v[64:67], v[80:83], v[192:207]
    ds_read_b64_tr_b16 v[48:49], v18 offset:16384
    v_mfma_f32_32x32x16_bf16 v[208:223], v[64:67], v[84:87], v[208:223]
    ds_read_b64_tr_b16 v[50:51], v18 offset:17408
    s_waitcnt lgkmcnt(6)
    v_mfma_f32_32x32x16_bf16 v[224:239], v[68:71], v[80:83], v[224:239]
    ds_read_b64_tr_b16 v[52:53], v19 offset:16384
    v_mfma_f32_32x32x16_bf16 v[240:255], v[68:71], v[84:87], v[240:255]
    ds_read_b64_tr_b16 v[54:55], v19 offset:17408
    ds_read_b128 v[72:75], v28 offset:0
    ds_read_b128 v[76:79], v28 offset:4096
    s_waitcnt lgkmcnt(8)
    v_mfma_f32_32x32x16_bf16 v[128:143], v[40:43], v[88:91], v[128:143]
    ds_read_b64_tr_b16 v[56:57], v16 offset:24576
    ds_read_b128 v[80:83], v29 offset:0
    ds_read_b128 v[84:87], v29 offset:4096
    v_mfma_f32_32x32x16_bf16 v[144:159], v[40:43], v[92:95], v[144:159]
    ds_read_b64_tr_b16 v[58:59], v16 offset:25600
    s_waitcnt lgkmcnt(10)
    v_mfma_f32_32x32x16_bf16 v[160:175], v[44:47], v[88:91], v[160:175]
    ds_read_b64_tr_b16 v[60:61], v17 offset:24576
    v_mfma_f32_32x32x16_bf16 v[176:191], v[44:47], v[92:95], v[176:191]
    ds_read_b64_tr_b16 v[62:63], v17 offset:25600
    s_waitcnt lgkmcnt(10)
    v_mfma_f32_32x32x16_bf16 v[192:207], v[48:51], v[88:91], v[192:207]
    ds_read_b64_tr_b16 v[64:65], v18 offset:24576
    v_mfma_f32_32x32x16_bf16 v[208:223], v[48:51], v[92:95], v[208:223]
    ds_read_b64_tr_b16 v[66:67], v18 offset:25600
    s_waitcnt lgkmcnt(10)
    v_mfma_f32_32x32x16_bf16 v[224:239], v[52:55], v[88:91], v[224:239]
    ds_read_b64_tr_b16 v[68:69], v19 offset:24576
    v_mfma_f32_32x32x16_bf16 v[240:255], v[52:55], v[92:95], v[240:255]
    ds_read_b64_tr_b16 v[70:71], v19 offset:25600
    ds_read_b128 v[88:91], v30 offset:0
    ds_read_b128 v[92:95], v30 offset:4096
    s_waitcnt lgkmcnt(8)
    v_mfma_f32_32x32x16_bf16 v[128:143], v[56:59], v[96:99], v[128:143]
    s_waitcnt vmcnt(2)
    s_barrier
    ds_read_b64_tr_b16 v[40:41], v16 offset:49152
    v_mfma_f32_32x32x16_bf16 v[144:159], v[56:59], v[100:103], v[144:159]
    ds_read_b64_tr_b16 v[42:43], v16 offset:50176
    s_add_u32 m0, s66, 8704
    s_nop 0
    buffer_load_dwordx4 v36, s[44:47], s76 offen lds
    buffer_load_dwordx4 v37, s[44:47], s76 offen offset:1024 lds
    s_add_u32 s76, s76, 114688
    s_add_u32 s77, s77, 1
    s_cmp_eq_u32 s77, 14
    s_cselect_b32 s74, 1605632, 0
    s_sub_u32 s76, s76, s74
    s_waitcnt lgkmcnt(8)
    v_mfma_f32_32x32x16_bf16 v[160:175], v[60:63], v[96:99], v[160:175]
    ds_read_b64_tr_b16 v[44:45], v17 offset:49152
    v_mfma_f32_32x32x16_bf16 v[176:191], v[60:63], v[100:103], v[176:191]
    ds_read_b64_tr_b16 v[46:47], v17 offset:50176
    s_waitcnt lgkmcnt(8)
    v_mfma_f32_32x32x16_bf16 v[192:207], v[64:67], v[96:99], v[192:207]
    ds_read_b64_tr_b16 v[48:49], v18 offset:49152
    v_mfma_f32_32x32x16_bf16 v[208:223], v[64:67], v[100:103], v[208:223]
    ds_read_b64_tr_b16 v[50:51], v18 offset:50176
    s_waitcnt lgkmcnt(8)
    v_mfma_f32_32x32x16_bf16 v[224:239], v[68:71], v[96:99], v[224:239]
    ds_read_b64_tr_b16 v[52:53], v19 offset:49152
    v_mfma_f32_32x32x16_bf16 v[240:255], v[68:71], v[100:103], v[240:255]
    ds_read_b64_tr_b16 v[54:55], v19 offset:50176
    ds_read_b128 v[96:99], v31 offset:0
    ds_read_b128 v[100:103], v31 offset:4096
    s_waitcnt lgkmcnt(8)
    v_mfma_f32_32x32x16_bf16 v[128:143], v[40:43], v[72:75], v[128:143]
    ds_read_b64_tr_b16 v[56:57], v16 offset:57344
    v_mfma_f32_32x32x16_bf16 v[144:159], v[40:43], v[76:79], v[144:159]
    ds_read_b64_tr_b16 v[58:59], v16 offset:58368
    s_waitcnt lgkmcnt(8)
    v_mfma_f32_32x32x16_bf16 v[160:175], v[44:47], v[72:75], v[160:175]
    ds_read_b64_tr_b16 v[60:61], v17 offset:57344
    v_mfma_f32_32x32x16_bf16 v[176:191], v[44:47], v[76:79], v[176:191]
    ds_read_b64_tr_b16 v[62:63], v17 offset:58368
    s_waitcnt lgkmcnt(8)
    v_mfma_f32_32x32x16_bf16 v[192:207], v[48:51], v[72:75], v[192:207]
    ds_read_b64_tr_b16 v[64:65], v18 offset:57344
    v_mfma_f32_32x32x16_bf16 v[208:223], v[48:51], v[76:79], v[208:223]
    ds_read_b64_tr_b16 v[66:67], v18 offset:58368
    s_waitcnt lgkmcnt(8)
    v_mfma_f32_32x32x16_bf16 v[224:239], v[52:55], v[72:75], v[224:239]
    ds_read_b64_tr_b16 v[68:69], v19 offset:57344
    v_mfma_f32_32x32x16_bf16 v[240:255], v[52:55], v[76:79], v[240:255]
    ds_read_b64_tr_b16 v[70:71], v19 offset:58368
    s_waitcnt lgkmcnt(6)
    v_mfma_f32_32x32x16_bf16 v[128:143], v[56:59], v[80:83], v[128:143]
    s_waitcnt vmcnt(2)
    s_barrier
    ds_read_b64_tr_b16 v[40:41], v20 offset:16384
    v_mfma_f32_32x32x16_bf16 v[144:159], v[56:59], v[84:87], v[144:159]
    ds_read_b64_tr_b16 v[42:43], v20 offset:17408
    s_add_u32 m0, s66, 0
    s_nop 0
    buffer_load_dwordx4 v36, s[44:47], s76 offen lds
    buffer_load_dwordx4 v37, s[44:47], s76 offen offset:1024 lds
    s_add_u32 s76, s76, 114688
    s_add_u32 s77, s77, 1
    s_cmp_eq_u32 s77, 14
    s_cselect_b32 s74, 1605632, 0
    s_sub_u32 s76, s76, s74
    s_waitcnt lgkmcnt(6)
    v_mfma_f32_32x32x16_bf16 v[160:175], v[60:63], v[80:83], v[160:175]
    ds_read_b64_tr_b16 v[44:45], v21 offset:16384
    v_mfma_f32_32x32x16_bf16 v[176:191], v[60:63], v[84:87], v[176:191]
    ds_read_b64_tr_b16 v[46:47], v21 offset:17408
    s_waitcnt lgkmcnt(6)
    v_mfma_f32_32x32x16_bf16 v[192:207], v[64:67], v[80:83], v[192:207]
    ds_read_b64_tr_b16 v[48:49], v22 offset:16384
    s_add_u32 m0, s66, 10752
    s_nop 0
    buffer_load_dwordx4 v36, s[44:47], s76 offen lds
    buffer_load_dwordx4 v37, s[44:47], s76 offen offset:1024 lds
    v_mfma_f32_32x32x16_bf16 v[208:223], v[64:67], v[84:87], v[208:223]
    ds_read_b64_tr_b16 v[50:51], v22 offset:17408
    s_waitcnt lgkmcnt(6)
    v_mfma_f32_32x32x16_bf16 v[224:239], v[68:71], v[80:83], v[224:239]
    ds_read_b64_tr_b16 v[52:53], v23 offset:16384
    v_mfma_f32_32x32x16_bf16 v[240:255], v[68:71], v[84:87], v[240:255]
    ds_read_b64_tr_b16 v[54:55], v23 offset:17408
    ds_read_b128 v[72:75], v24 offset:0
    ds_read_b128 v[76:79], v24 offset:4096
    s_waitcnt lgkmcnt(8)
    v_mfma_f32_32x32x16_bf16 v[128:143], v[40:43], v[88:91], v[128:143]
    ds_read_b64_tr_b16 v[56:57], v20 offset:24576
    ds_read_b128 v[80:83], v25 offset:0
    ds_read_b128 v[84:87], v25 offset:4096
    v_mfma_f32_32x32x16_bf16 v[144:159], v[40:43], v[92:95], v[144:159]
    ds_read_b64_tr_b16 v[58:59], v20 offset:25600
    s_waitcnt lgkmcnt(10)
    v_mfma_f32_32x32x16_bf16 v[160:175], v[44:47], v[88:91], v[160:175]
    ds_read_b64_tr_b16 v[60:61], v21 offset:24576
    v_mfma_f32_32x32x16_bf16 v[176:191], v[44:47], v[92:95], v[176:191]
    ds_read_b64_tr_b16 v[62:63], v21 offset:25600
    s_waitcnt lgkmcnt(10)
    v_mfma_f32_32x32x16_bf16 v[192:207], v[48:51], v[88:91], v[192:207]
    ds_read_b64_tr_b16 v[64:65], v22 offset:24576
    v_mfma_f32_32x32x16_bf16 v[208:223], v[48:51], v[92:95], v[208:223]
    ds_read_b64_tr_b16 v[66:67], v22 offset:25600
    s_waitcnt lgkmcnt(10)
    v_mfma_f32_32x32x16_bf16 v[224:239], v[52:55], v[88:91], v[224:239]
    ds_read_b64_tr_b16 v[68:69], v23 offset:24576
    v_mfma_f32_32x32x16_bf16 v[240:255], v[52:55], v[92:95], v[240:255]
    ds_read_b64_tr_b16 v[70:71], v23 offset:25600
    ds_read_b128 v[88:91], v26 offset:0
    ds_read_b128 v[92:95], v26 offset:4096
    s_waitcnt lgkmcnt(8)
    v_mfma_f32_32x32x16_bf16 v[128:143], v[56:59], v[96:99], v[128:143]
    s_waitcnt vmcnt(4)
    s_barrier
    ds_read_b64_tr_b16 v[40:41], v20 offset:32768
    v_mfma_f32_32x32x16_bf16 v[144:159], v[56:59], v[100:103], v[144:159]
    ds_read_b64_tr_b16 v[42:43], v20 offset:33792
    s_waitcnt lgkmcnt(8)
    v_mfma_f32_32x32x16_bf16 v[160:175], v[60:63], v[96:99], v[160:175]
    ds_read_b64_tr_b16 v[44:45], v21 offset:32768
    v_mfma_f32_32x32x16_bf16 v[176:191], v[60:63], v[100:103], v[176:191]
    ds_read_b64_tr_b16 v[46:47], v21 offset:33792
    s_waitcnt lgkmcnt(8)
    v_mfma_f32_32x32x16_bf16 v[192:207], v[64:67], v[96:99], v[192:207]
    ds_read_b64_tr_b16 v[48:49], v22 offset:32768
    v_mfma_f32_32x32x16_bf16 v[208:223], v[64:67], v[100:103], v[208:223]
    ds_read_b64_tr_b16 v[50:51], v22 offset:33792
    s_waitcnt lgkmcnt(8)
    v_mfma_f32_32x32x16_bf16 v[224:239], v[68:71], v[96:99], v[224:239]
    ds_read_b64_tr_b16 v[52:53], v23 offset:32768
    v_mfma_f32_32x32x16_bf16 v[240:255], v[68:71], v[100:103], v[240:255]
    ds_read_b64_tr_b16 v[54:55], v23 offset:33792
    ds_read_b128 v[96:99], v27 offset:0
    ds_read_b128 v[100:103], v27 offset:4096
    s_waitcnt lgkmcnt(8)
    v_mfma_f32_32x32x16_bf16 v[128:143], v[40:43], v[72:75], v[128:143]
    ds_read_b64_tr_b16 v[56:57], v20 offset:40960
    s_mov_b32 s77, s63
    s_lshl_b32 s54, s77, 3
    v_mfma_f32_32x32x16_bf16 v[144:159], v[40:43], v[76:79], v[144:159]
    ds_read_b64_tr_b16 v[58:59], v20 offset:41984
    s_add_u32 s54, s54, s78
    s_add_u32 s54, s54, 0
    s_waitcnt lgkmcnt(8)
    v_mfma_f32_32x32x16_bf16 v[160:175], v[44:47], v[72:75], v[160:175]
    ds_read_b64_tr_b16 v[60:61], v21 offset:40960
    s_mul_i32 s54, s54, 14336
    s_lshl_b32 s55, s62, 7
    v_mfma_f32_32x32x16_bf16 v[176:191], v[44:47], v[76:79], v[176:191]
    ds_read_b64_tr_b16 v[62:63], v21 offset:41984
    s_add_u32 s76, s54, s55
    s_waitcnt lgkmcnt(8)
    v_mfma_f32_32x32x16_bf16 v[192:207], v[48:51], v[72:75], v[192:207]
    ds_read_b64_tr_b16 v[64:65], v22 offset:40960
    v_mfma_f32_32x32x16_bf16 v[208:223], v[48:51], v[76:79], v[208:223]
    ds_read_b64_tr_b16 v[66:67], v22 offset:41984
    s_waitcnt lgkmcnt(8)
    v_mfma_f32_32x32x16_bf16 v[224:239], v[52:55], v[72:75], v[224:239]
    ds_read_b64_tr_b16 v[68:69], v23 offset:40960
    v_mfma_f32_32x32x16_bf16 v[240:255], v[52:55], v[76:79], v[240:255]
    ds_read_b64_tr_b16 v[70:71], v23 offset:41984
    s_waitcnt lgkmcnt(6)
    v_mfma_f32_32x32x16_bf16 v[128:143], v[56:59], v[80:83], v[128:143]
    s_waitcnt vmcnt(0)
    s_barrier
    ds_read_b64_tr_b16 v[40:41], v16 offset:16384
    v_mfma_f32_32x32x16_bf16 v[144:159], v[56:59], v[84:87], v[144:159]
    ds_read_b64_tr_b16 v[42:43], v16 offset:17408
    s_waitcnt lgkmcnt(6)
    v_mfma_f32_32x32x16_bf16 v[160:175], v[60:63], v[80:83], v[160:175]
    ds_read_b64_tr_b16 v[44:45], v17 offset:16384
    s_add_u32 m0, s70, 81920
    s_nop 0
    buffer_load_dwordx4 v36, s[44:47], s76 offen lds
    buffer_load_dwordx4 v37, s[44:47], s76 offen offset:1024 lds
    s_add_u32 s76, s76, 114688
    s_add_u32 s77, s77, 1
    s_cmp_eq_u32 s77, 14
    s_cselect_b32 s74, 1605632, 0
    s_sub_u32 s76, s76, s74
    v_mfma_f32_32x32x16_bf16 v[176:191], v[60:63], v[84:87], v[176:191]
    ds_read_b64_tr_b16 v[46:47], v17 offset:17408
    s_waitcnt lgkmcnt(6)
    v_mfma_f32_32x32x16_bf16 v[192:207], v[64:67], v[80:83], v[192:207]
    ds_read_b64_tr_b16 v[48:49], v18 offset:16384
    v_mfma_f32_32x32x16_bf16 v[208:223], v[64:67], v[84:87], v[208:223]
    ds_read_b64_tr_b16 v[50:51], v18 offset:17408
    s_add_u32 m0, s70, 83968
    s_nop 0
    buffer_load_dwordx4 v36, s[44:47], s76 offen lds
    buffer_load_dwordx4 v37, s[44:47], s76 offen offset:1024 lds
    s_add_u32 s76, s76, 114688
    s_add_u32 s77, s77, 1
    s_cmp_eq_u32 s77, 14
    s_cselect_b32 s74, 1605632, 0
    s_sub_u32 s76, s76, s74
    s_waitcnt lgkmcnt(6)
    v_mfma_f32_32x32x16_bf16 v[224:239], v[68:71], v[80:83], v[224:239]
    ds_read_b64_tr_b16 v[52:53], v19 offset:16384
    v_mfma_f32_32x32x16_bf16 v[240:255], v[68:71], v[84:87], v[240:255]
    ds_read_b64_tr_b16 v[54:55], v19 offset:17408
    ds_read_b128 v[72:75], v24 offset:32768
    ds_read_b128 v[76:79], v24 offset:36864
    s_waitcnt lgkmcnt(8)
    v_mfma_f32_32x32x16_bf16 v[128:143], v[40:43], v[88:91], v[128:143]
    ds_read_b64_tr_b16 v[56:57], v16 offset:24576
    ds_read_b128 v[80:83], v25 offset:32768
    ds_read_b128 v[84:87], v25 offset:36864
    v_mfma_f32_32x32x16_bf16 v[144:159], v[40:43], v[92:95], v[144:159]
    ds_read_b64_tr_b16 v[58:59], v16 offset:25600
    s_waitcnt lgkmcnt(10)
    v_mfma_f32_32x32x16_bf16 v[160:175], v[44:47], v[88:91], v[160:175]
    ds_read_b64_tr_b16 v[60:61], v17 offset:24576
    v_mfma_f32_32x32x16_bf16 v[176:191], v[44:47], v[92:95], v[176:191]
    ds_read_b64_tr_b16 v[62:63], v17 offset:25600
    s_waitcnt lgkmcnt(10)
    v_mfma_f32_32x32x16_bf16 v[192:207], v[48:51], v[88:91], v[192:207]
    ds_read_b64_tr_b16 v[64:65], v18 offset:24576
    v_mfma_f32_32x32x16_bf16 v[208:223], v[48:51], v[92:95], v[208:223]
    ds_read_b64_tr_b16 v[66:67], v18 offset:25600
    s_waitcnt lgkmcnt(10)
    v_mfma_f32_32x32x16_bf16 v[224:239], v[52:55], v[88:91], v[224:239]
    ds_read_b64_tr_b16 v[68:69], v19 offset:24576
    v_mfma_f32_32x32x16_bf16 v[240:255], v[52:55], v[92:95], v[240:255]
    ds_read_b64_tr_b16 v[70:71], v19 offset:25600
    ds_read_b128 v[88:91], v26 offset:32768
    ds_read_b128 v[92:95], v26 offset:36864
    s_waitcnt lgkmcnt(8)
    v_mfma_f32_32x32x16_bf16 v[128:143], v[56:59], v[96:99], v[128:143]
    s_barrier
    ds_read_b64_tr_b16 v[40:41], v16 offset:49152
    v_mfma_f32_32x32x16_bf16 v[144:159], v[56:59], v[100:103], v[144:159]
    ds_read_b64_tr_b16 v[42:43], v16 offset:50176
    buffer_load_dword v126, v33, s[36:39], s68 offen sc1
    buffer_load_dword v127, v33, s[36:39], s68 offen offset:256 sc1
    buffer_load_dwordx4 v[104:107], v15, s[36:39], s69 offen sc1
    s_lshl_b32 s54, s61, 12
    s_waitcnt lgkmcnt(8)
    v_mfma_f32_32x32x16_bf16 v[160:175], v[60:63], v[96:99], v[160:175]
    ds_read_b64_tr_b16 v[44:45], v16 offset:57344
    s_lshl_b32 s55, s80, 7
    s_add_u32 s54, s54, s55
    v_mfma_f32_32x32x16_bf16 v[176:191], v[60:63], v[100:103], v[176:191]
    ds_read_b64_tr_b16 v[46:47], v16 offset:58368
    s_add_u32 s67, s54, 14811136
    s_mov_b32 s4, s67
    s_add_u32 s22, s34, s67
    s_addc_u32 s23, s35, 0
    s_waitcnt lgkmcnt(8)
    v_mfma_f32_32x32x16_bf16 v[192:207], v[64:67], v[96:99], v[192:207]
    ds_read_b64_tr_b16 v[48:49], v20 offset:0
    s_add_u32 m0, s70, 98304
    s_nop 0
    buffer_load_dwordx4 v36, s[44:47], s76 offen lds
    buffer_load_dwordx4 v37, s[44:47], s76 offen offset:1024 lds
    s_add_u32 s76, s76, 114688
    s_add_u32 s77, s77, 1
    s_cmp_eq_u32 s77, 14
    s_cselect_b32 s74, 1605632, 0
    s_sub_u32 s76, s76, s74
    v_bfe_u32 v2, v1, 3, 1
    v_mfma_f32_32x32x16_bf16 v[208:223], v[64:67], v[100:103], v[208:223]
    ds_read_b64_tr_b16 v[50:51], v20 offset:1024
    v_lshrrev_b32 v3, 4, v1
    v_lshl_add_u32 v3, v2, 2, v3
    s_waitcnt lgkmcnt(8)
    v_mfma_f32_32x32x16_bf16 v[224:239], v[68:71], v[96:99], v[224:239]
    ds_read_b64_tr_b16 v[52:53], v20 offset:8192
    v_mul_u32_u24 v2, 896, v3
    v_and_b32 v4, 7, v1
    v_mfma_f32_32x32x16_bf16 v[240:255], v[68:71], v[100:103], v[240:255]
    ds_read_b64_tr_b16 v[54:55], v20 offset:9216
    ds_read_b128 v[96:99], v27 offset:32768
    ds_read_b128 v[100:103], v27 offset:36864
    s_waitcnt lgkmcnt(8)
    v_mfma_f32_32x32x16_bf16 v[128:143], v[40:43], v[72:75], v[128:143]
    ds_read_b64_tr_b16 v[56:57], v17 offset:49152
    s_waitcnt vmcnt(2)
    v_cmp_gt_u32 vcc, 32, v1
    v_xor_b32 v126, 0x80000000, v126
    v_lshrrev_b32 v33, 16, v126
    v_or_b32 v126, v126, v33
    v_lshl_add_u32 v2, v4, 4, v2
    v_mfma_f32_32x32x16_bf16 v[144:159], v[40:43], v[76:79], v[144:159]
    ds_read_b64_tr_b16 v[58:59], v17 offset:50176
    v_cndmask_b32 v111, 0, v33, vcc
    v_cndmask_b32_e64 v115, v33, 0, vcc
    v_cndmask_b32 v110, 0, v126, vcc
    v_cndmask_b32_e64 v114, v126, 0, vcc
    v_lshlrev_b32 v3, 3, v3
    s_waitcnt lgkmcnt(8)
    v_mfma_f32_32x32x16_bf16 v[128:143], v[44:47], v[80:83], v[128:143]
    ds_read_b64_tr_b16 v[60:61], v17 offset:57344
    v_xor_b32 v127, 0x80000000, v127
    v_lshrrev_b32 v33, 16, v127
    v_or_b32 v127, v127, v33
    v_cndmask_b32 v119, 0, v33, vcc
    s_lshl_b32 s54, s61, 3
    v_mfma_f32_32x32x16_bf16 v[144:159], v[44:47], v[84:87], v[144:159]
    ds_read_b64_tr_b16 v[62:63], v17 offset:58368
    v_cndmask_b32_e64 v123, v33, 0, vcc
    v_cndmask_b32 v118, 0, v127, vcc
    v_cndmask_b32_e64 v122, v127, 0, vcc
    s_add_u32 s54, s54, s3
    s_lshl_b32 s56, s54, 6
    s_waitcnt lgkmcnt(8)
    v_mfma_f32_32x32x16_bf16 v[128:143], v[48:51], v[88:91], v[128:143]
    ds_read_b64_tr_b16 v[64:65], v21 offset:0
    s_add_u32 s56, s56, 32768
    s_mul_i32 s54, s54, 7168
    s_lshl_b32 s55, s62, 7
    s_add_u32 s71, s54, s55
    buffer_load_dwordx4 v[4:7], v2, s[40:43], s71 offen
    v_mfma_f32_32x32x16_bf16 v[144:159], v[48:51], v[92:95], v[144:159]
    ds_read_b64_tr_b16 v[66:67], v21 offset:1024
    buffer_load_dword v3, v3, s[36:39], s56 offen offset:4 sc1
    s_add_u32 m0, s70, 100352
    s_nop 0
    buffer_load_dwordx4 v36, s[44:47], s76 offen lds
    buffer_load_dwordx4 v37, s[44:47], s76 offen offset:1024 lds
    s_add_u32 s76, s76, 114688
    s_add_u32 s77, s77, 1
    s_cmp_eq_u32 s77, 14
    s_cselect_b32 s74, 1605632, 0
    s_sub_u32 s76, s76, s74
    s_add_u32 m0, s70, 0
    s_nop 0
    buffer_load_dwordx4 v36, s[44:47], s76 offen lds
    buffer_load_dwordx4 v37, s[44:47], s76 offen offset:1024 lds
    s_add_u32 s76, s76, 114688
    s_add_u32 s77, s77, 1
    s_cmp_eq_u32 s77, 14
    s_cselect_b32 s74, 1605632, 0
    s_sub_u32 s76, s76, s74
    s_add_u32 m0, s70, 2048
    s_nop 0
    buffer_load_dwordx4 v36, s[44:47], s76 offen lds
    buffer_load_dwordx4 v37, s[44:47], s76 offen offset:1024 lds
    s_add_u32 s76, s76, 114688
    s_add_u32 s77, s77, 1
    s_cmp_eq_u32 s77, 14
    s_cselect_b32 s74, 1605632, 0
    s_sub_u32 s76, s76, s74
    s_waitcnt lgkmcnt(6)
    v_mfma_f32_32x32x16_bf16 v[128:143], v[52:55], v[96:99], v[128:143]
    ds_read_b64_tr_b16 v[68:69], v21 offset:8192
    v_mfma_f32_32x32x16_bf16 v[144:159], v[52:55], v[100:103], v[144:159]
    ds_read_b64_tr_b16 v[70:71], v21 offset:9216
    v_mfma_f32_32x32x16_bf16 v[128:143], v[104:107], v[110:113], v[128:143]
    v_mfma_f32_32x32x16_bf16 v[144:159], v[104:107], v[118:121], v[144:159]
    s_waitcnt lgkmcnt(6)
    v_mfma_f32_32x32x16_bf16 v[160:175], v[56:59], v[72:75], v[160:175]
    ds_read_b64_tr_b16 v[40:41], v18 offset:49152
    v_mfma_f32_32x32x16_bf16 v[176:191], v[56:59], v[76:79], v[176:191]
    ds_read_b64_tr_b16 v[42:43], v18 offset:50176
    s_waitcnt lgkmcnt(6)
    v_mfma_f32_32x32x16_bf16 v[160:175], v[60:63], v[80:83], v[160:175]
    ds_read_b64_tr_b16 v[44:45], v18 offset:57344
    s_nop 2
    v_max_f32 v128, 0, v128
    v_max_f32 v129, 0, v129
    v_mul_f32 v128, v128, v136
    v_mul_f32 v129, v129, v137
    v_mfma_f32_32x32x16_bf16 v[176:191], v[60:63], v[84:87], v[176:191]
    ds_read_b64_tr_b16 v[46:47], v18 offset:58368
    v_max_f32 v130, 0, v130
    v_max_f32 v131, 0, v131
    v_mul_f32 v130, v130, v138
    v_mul_f32 v131, v131, v139
    s_waitcnt lgkmcnt(6)
    v_mfma_f32_32x32x16_bf16 v[160:175], v[64:67], v[88:91], v[160:175]
    ds_read_b64_tr_b16 v[48:49], v22 offset:0
    v_cvt_pk_bf16_f32 v128, v128, v129
    v_max_f32 v132, 0, v132
    v_max_f32 v133, 0, v133
    v_mul_f32 v132, v132, v140
    v_mfma_f32_32x32x16_bf16 v[176:191], v[64:67], v[92:95], v[176:191]
    ds_read_b64_tr_b16 v[50:51], v22 offset:1024
    v_mul_f32 v133, v133, v141
    v_cvt_pk_bf16_f32 v129, v130, v131
    v_max_f32 v134, 0, v134
    v_max_f32 v135, 0, v135
    s_waitcnt lgkmcnt(6)
    v_mfma_f32_32x32x16_bf16 v[160:175], v[68:71], v[96:99], v[160:175]
    ds_read_b64_tr_b16 v[52:53], v22 offset:8192
    v_mul_f32 v134, v134, v142
    v_mul_f32 v135, v135, v143
    v_cvt_pk_bf16_f32 v130, v132, v133
    v_cvt_pk_bf16_f32 v131, v134, v135
    v_mfma_f32_32x32x16_bf16 v[176:191], v[68:71], v[100:103], v[176:191]
    ds_read_b64_tr_b16 v[54:55], v22 offset:9216
    buffer_store_dwordx4 v[128:131], v15, s[36:39], s85 offen offset:0 sc1
    v_max_f32 v144, 0, v144
    v_max_f32 v145, 0, v145
    v_mfma_f32_32x32x16_bf16 v[160:175], v[104:107], v[108:111], v[160:175]
    v_mul_f32 v144, v144, v152
    v_mul_f32 v145, v145, v153
    v_max_f32 v146, 0, v146
    v_max_f32 v147, 0, v147
    v_mul_f32 v146, v146, v154
    v_mfma_f32_32x32x16_bf16 v[176:191], v[104:107], v[116:119], v[176:191]
    v_mul_f32 v147, v147, v155
    v_cvt_pk_bf16_f32 v144, v144, v145
    v_max_f32 v148, 0, v148
    v_max_f32 v149, 0, v149
    v_mul_f32 v148, v148, v156
    s_waitcnt lgkmcnt(6)
    v_mfma_f32_32x32x16_bf16 v[192:207], v[40:43], v[72:75], v[192:207]
    ds_read_b64_tr_b16 v[56:57], v19 offset:49152
    v_mul_f32 v149, v149, v157
    v_cvt_pk_bf16_f32 v145, v146, v147
    v_max_f32 v150, 0, v150
    v_max_f32 v151, 0, v151
    v_mfma_f32_32x32x16_bf16 v[208:223], v[40:43], v[76:79], v[208:223]
    ds_read_b64_tr_b16 v[58:59], v19 offset:50176
    v_mul_f32 v150, v150, v158
    v_mul_f32 v151, v151, v159
    v_cvt_pk_bf16_f32 v146, v148, v149
    v_cvt_pk_bf16_f32 v147, v150, v151
    s_barrier
    s_waitcnt lgkmcnt(6)
    v_mfma_f32_32x32x16_bf16 v[192:207], v[44:47], v[80:83], v[192:207]
    ds_read_b64_tr_b16 v[60:61], v19 offset:57344
    buffer_store_dwordx4 v[144:147], v15, s[36:39], s84 offen offset:0 sc1
    v_max_f32 v160, 0, v160
    v_max_f32 v161, 0, v161
    v_mfma_f32_32x32x16_bf16 v[208:223], v[44:47], v[84:87], v[208:223]
    ds_read_b64_tr_b16 v[62:63], v19 offset:58368
    v_mul_f32 v160, v160, v168
    v_mul_f32 v161, v161, v169
    v_max_f32 v162, 0, v162
    v_max_f32 v163, 0, v163
    s_waitcnt lgkmcnt(6)
    v_mfma_f32_32x32x16_bf16 v[192:207], v[48:51], v[88:91], v[192:207]
    ds_read_b64_tr_b16 v[64:65], v23 offset:0
    v_mul_f32 v162, v162, v170
    v_mul_f32 v163, v163, v171
    v_cvt_pk_bf16_f32 v160, v160, v161
    v_max_f32 v164, 0, v164
    v_mfma_f32_32x32x16_bf16 v[208:223], v[48:51], v[92:95], v[208:223]
    ds_read_b64_tr_b16 v[66:67], v23 offset:1024
    v_max_f32 v165, 0, v165
    v_mul_f32 v164, v164, v172
    v_mul_f32 v165, v165, v173
    v_cvt_pk_bf16_f32 v161, v162, v163
    s_waitcnt lgkmcnt(6)
    v_mfma_f32_32x32x16_bf16 v[192:207], v[52:55], v[96:99], v[192:207]
    ds_read_b64_tr_b16 v[68:69], v23 offset:8192
    v_max_f32 v166, 0, v166
    v_max_f32 v167, 0, v167
    v_mul_f32 v166, v166, v174
    v_mul_f32 v167, v167, v175
    v_mfma_f32_32x32x16_bf16 v[208:223], v[52:55], v[100:103], v[208:223]
    ds_read_b64_tr_b16 v[70:71], v23 offset:9216
    v_cvt_pk_bf16_f32 v162, v164, v165
    v_cvt_pk_bf16_f32 v163, v166, v167
    buffer_store_dwordx4 v[160:163], v15, s[36:39], s85 offen offset:1024 sc1
    v_mfma_f32_32x32x16_bf16 v[192:207], v[104:107], v[114:117], v[192:207]
    v_max_f32 v176, 0, v176
    v_max_f32 v177, 0, v177
    v_mul_f32 v176, v176, v184
    v_mul_f32 v177, v177, v185
    v_max_f32 v178, 0, v178
    v_mfma_f32_32x32x16_bf16 v[208:223], v[104:107], v[122:125], v[208:223]
    v_max_f32 v179, 0, v179
    v_mul_f32 v178, v178, v186
    v_mul_f32 v179, v179, v187
    v_cvt_pk_bf16_f32 v176, v176, v177
    v_max_f32 v180, 0, v180
    s_waitcnt lgkmcnt(6)
    v_mfma_f32_32x32x16_bf16 v[224:239], v[56:59], v[72:75], v[224:239]
    v_max_f32 v181, 0, v181
    v_mul_f32 v180, v180, v188
    v_mul_f32 v181, v181, v189
    v_cvt_pk_bf16_f32 v177, v178, v179
    v_mfma_f32_32x32x16_bf16 v[240:255], v[56:59], v[76:79], v[240:255]
    v_max_f32 v182, 0, v182
    v_max_f32 v183, 0, v183
    v_mul_f32 v182, v182, v190
    v_mul_f32 v183, v183, v191
    s_waitcnt lgkmcnt(4)
    v_mfma_f32_32x32x16_bf16 v[224:239], v[60:63], v[80:83], v[224:239]
    v_cvt_pk_bf16_f32 v178, v180, v181
    v_cvt_pk_bf16_f32 v179, v182, v183
    buffer_store_dwordx4 v[176:179], v15, s[36:39], s84 offen offset:1024 sc1
    v_mfma_f32_32x32x16_bf16 v[240:255], v[60:63], v[84:87], v[240:255]
    v_max_f32 v192, 0, v192
    v_max_f32 v193, 0, v193
    v_mul_f32 v192, v192, v200
    v_mul_f32 v193, v193, v201
    s_waitcnt lgkmcnt(2)
    v_mfma_f32_32x32x16_bf16 v[224:239], v[64:67], v[88:91], v[224:239]
    v_max_f32 v194, 0, v194
    v_max_f32 v195, 0, v195
    v_mul_f32 v194, v194, v202
    v_mul_f32 v195, v195, v203
    v_mfma_f32_32x32x16_bf16 v[240:255], v[64:67], v[92:95], v[240:255]
    v_cvt_pk_bf16_f32 v192, v192, v193
    v_max_f32 v196, 0, v196
    v_max_f32 v197, 0, v197
    v_mul_f32 v196, v196, v204
    s_waitcnt lgkmcnt(0)
    v_mfma_f32_32x32x16_bf16 v[224:239], v[68:71], v[96:99], v[224:239]
    v_mul_f32 v197, v197, v205
    v_cvt_pk_bf16_f32 v193, v194, v195
    v_max_f32 v198, 0, v198
    v_max_f32 v199, 0, v199
    v_mfma_f32_32x32x16_bf16 v[240:255], v[68:71], v[100:103], v[240:255]
    v_mul_f32 v198, v198, v206
    v_mul_f32 v199, v199, v207
    v_cvt_pk_bf16_f32 v194, v196, v197
    v_cvt_pk_bf16_f32 v195, v198, v199
    v_mfma_f32_32x32x16_bf16 v[224:239], v[104:107], v[112:115], v[224:239]
    buffer_store_dwordx4 v[192:195], v15, s[36:39], s85 offen offset:2048 sc1
    v_max_f32 v208, 0, v208
    v_max_f32 v209, 0, v209
    v_mul_f32 v208, v208, v216
    v_mfma_f32_32x32x16_bf16 v[240:255], v[104:107], v[120:123], v[240:255]
    v_mul_f32 v209, v209, v217
    v_max_f32 v210, 0, v210
    v_max_f32 v211, 0, v211
    v_mul_f32 v210, v210, v218
    v_mul_f32 v211, v211, v219
    v_cvt_pk_bf16_f32 v208, v208, v209
    v_max_f32 v212, 0, v212
    v_max_f32 v213, 0, v213
    v_mul_f32 v212, v212, v220
    v_mul_f32 v213, v213, v221
    v_cvt_pk_bf16_f32 v209, v210, v211
    v_max_f32 v214, 0, v214
    v_max_f32 v215, 0, v215
    v_mul_f32 v214, v214, v222
    v_mul_f32 v215, v215, v223
    v_cvt_pk_bf16_f32 v210, v212, v213
    v_cvt_pk_bf16_f32 v211, v214, v215
    buffer_store_dwordx4 v[208:211], v15, s[36:39], s84 offen offset:2048 sc1
    v_max_f32 v224, 0, v224
    v_max_f32 v225, 0, v225
    v_mul_f32 v224, v224, v232
    v_mul_f32 v225, v225, v233
    v_max_f32 v226, 0, v226
    v_max_f32 v227, 0, v227
    v_mul_f32 v226, v226, v234
    v_mul_f32 v227, v227, v235
    v_cvt_pk_bf16_f32 v224, v224, v225
    v_max_f32 v228, 0, v228
    v_max_f32 v229, 0, v229
    v_mul_f32 v228, v228, v236
    v_mul_f32 v229, v229, v237
    v_cvt_pk_bf16_f32 v225, v226, v227
    v_max_f32 v230, 0, v230
    v_max_f32 v231, 0, v231
    v_mul_f32 v230, v230, v238
    v_mul_f32 v231, v231, v239
    v_cvt_pk_bf16_f32 v226, v228, v229
    v_cvt_pk_bf16_f32 v227, v230, v231
    buffer_store_dwordx4 v[224:227], v15, s[36:39], s85 offen offset:3072 sc1
    v_max_f32 v240, 0, v240
    v_max_f32 v241, 0, v241
    v_mul_f32 v240, v240, v248
    v_mul_f32 v241, v241, v249
    v_max_f32 v242, 0, v242
    v_max_f32 v243, 0, v243
    v_mul_f32 v242, v242, v250
    v_mul_f32 v243, v243, v251
    v_cvt_pk_bf16_f32 v240, v240, v241
    v_max_f32 v244, 0, v244
    v_max_f32 v245, 0, v245
    v_mul_f32 v244, v244, v252
    v_mul_f32 v245, v245, v253
    v_cvt_pk_bf16_f32 v241, v242, v243
    v_max_f32 v246, 0, v246
    v_max_f32 v247, 0, v247
    v_mul_f32 v246, v246, v254
    v_mul_f32 v247, v247, v255
    v_cvt_pk_bf16_f32 v242, v244, v245
    v_cvt_pk_bf16_f32 v243, v246, v247
    buffer_store_dwordx4 v[240:243], v15, s[36:39], s84 offen offset:3072 sc1
    s_mov_b32 s57, s71
    s_waitcnt vmcnt(4)
    v_mov_b32 v14, s52
    v_lshlrev_b32 v15, 19, v1
    s_mov_b64 exec, 15
    buffer_store_dword v14, v15, s[36:39], s83 offen sc1
    s_mov_b64 exec, -1
    s_add_u32 s83, s83, 131072
    s_add_u32 m0, s70, 16384
    s_nop 0
    buffer_load_dwordx4 v36, s[44:47], s76 offen lds
    buffer_load_dwordx4 v37, s[44:47], s76 offen offset:1024 lds
    s_add_u32 s76, s76, 114688
    s_add_u32 s77, s77, 1
    s_cmp_eq_u32 s77, 14
    s_cselect_b32 s74, 1605632, 0
    s_sub_u32 s76, s76, s74
    s_add_u32 m0, s70, 18432
    s_nop 0
    buffer_load_dwordx4 v36, s[44:47], s76 offen lds
    buffer_load_dwordx4 v37, s[44:47], s76 offen offset:1024 lds
    s_add_u32 s76, s76, 114688
    s_add_u32 s77, s77, 1
    s_cmp_eq_u32 s77, 14
    s_cselect_b32 s74, 1605632, 0
    s_sub_u32 s76, s76, s74
    s_waitcnt vmcnt(5)
    v_mov_b32 v14, s52
    v_lshlrev_b32 v15, 19, v1
    s_mov_b64 exec, 15
    buffer_store_dword v14, v15, s[36:39], s83 offen sc1
    s_mov_b64 exec, -1
    s_setprio 0
    s_add_u32 m0, s70, 32768
    s_nop 0
    buffer_load_dwordx4 v36, s[44:47], s76 offen lds
    buffer_load_dwordx4 v37, s[44:47], s76 offen offset:1024 lds
    s_add_u32 s76, s76, 114688
    s_add_u32 s77, s77, 1
    s_cmp_eq_u32 s77, 14
    s_cselect_b32 s74, 1605632, 0
    s_sub_u32 s76, s76, s74
    s_add_u32 m0, s70, 34816
    s_nop 0
    buffer_load_dwordx4 v36, s[44:47], s76 offen lds
    buffer_load_dwordx4 v37, s[44:47], s76 offen offset:1024 lds
    s_add_u32 s76, s76, 114688
    s_add_u32 s77, s77, 1
    s_cmp_eq_u32 s77, 14
    s_cselect_b32 s74, 1605632, 0
    s_sub_u32 s76, s76, s74
    ds_read_b64_tr_b16 v[144:145], v34 offset:16384
    ds_read_b64_tr_b16 v[146:147], v34 offset:17408
    ds_read_b64_tr_b16 v[148:149], v35 offset:16384
    ds_read_b64_tr_b16 v[150:151], v35 offset:17408
    ds_read_b64_tr_b16 v[152:153], v34 offset:18432
    ds_read_b64_tr_b16 v[154:155], v34 offset:19456
    ds_read_b64_tr_b16 v[156:157], v35 offset:18432
    ds_read_b64_tr_b16 v[158:159], v35 offset:19456
    ds_read_b64_tr_b16 v[160:161], v34 offset:32768
    ds_read_b64_tr_b16 v[162:163], v34 offset:33792
    ds_read_b64_tr_b16 v[164:165], v35 offset:32768
    ds_read_b64_tr_b16 v[166:167], v35 offset:33792
    ds_read_b64_tr_b16 v[168:169], v34 offset:34816
    ds_read_b64_tr_b16 v[170:171], v34 offset:35840
    ds_read_b64_tr_b16 v[172:173], v35 offset:34816
    ds_read_b64_tr_b16 v[174:175], v35 offset:35840
    s_waitcnt lgkmcnt(12)
    s_add_u32 m0, s70, 81920
    s_nop 0
    buffer_load_dwordx4 v36, s[44:47], s76 offen lds
    buffer_load_dwordx4 v37, s[44:47], s76 offen offset:1024 lds
    s_add_u32 s76, s76, 114688
    s_add_u32 s77, s77, 1
    s_cmp_eq_u32 s77, 14
    s_cselect_b32 s74, 1605632, 0
    s_sub_u32 s76, s76, s74
    s_waitcnt lgkmcnt(8)
    s_add_u32 m0, s70, 83968
    s_nop 0
    buffer_load_dwordx4 v36, s[44:47], s76 offen lds
    buffer_load_dwordx4 v37, s[44:47], s76 offen offset:1024 lds
    s_add_u32 s76, s76, 114688
    s_add_u32 s77, s77, 1
    s_cmp_eq_u32 s77, 14
    s_cselect_b32 s74, 1605632, 0
    s_sub_u32 s76, s76, s74
    s_waitcnt lgkmcnt(4)
    s_add_u32 m0, s70, 98304
    s_nop 0
    buffer_load_dwordx4 v36, s[44:47], s76 offen lds
    buffer_load_dwordx4 v37, s[44:47], s76 offen offset:1024 lds
    s_add_u32 s76, s76, 114688
    s_add_u32 s77, s77, 1
    s_cmp_eq_u32 s77, 14
    s_cselect_b32 s74, 1605632, 0
    s_sub_u32 s76, s76, s74
    s_waitcnt lgkmcnt(0)
    s_add_u32 m0, s70, 100352
    s_nop 0
    buffer_load_dwordx4 v36, s[44:47], s76 offen lds
    buffer_load_dwordx4 v37, s[44:47], s76 offen offset:1024 lds
    s_mov_b32 s70, s57
    ds_read_b64_tr_b16 v[176:177], v38 offset:0
    ds_read_b64_tr_b16 v[178:179], v38 offset:1024
    ds_read_b64_tr_b16 v[180:181], v39 offset:0
    ds_read_b64_tr_b16 v[182:183], v39 offset:1024
    ds_read_b64_tr_b16 v[184:185], v38 offset:2048
    ds_read_b64_tr_b16 v[186:187], v38 offset:3072
    ds_read_b64_tr_b16 v[188:189], v39 offset:2048
    ds_read_b64_tr_b16 v[190:191], v39 offset:3072
    s_waitcnt vmcnt(15)
    ds_read_b64_tr_b16 v[192:193], v38 offset:16384
    ds_read_b64_tr_b16 v[194:195], v38 offset:17408
    ds_read_b64_tr_b16 v[196:197], v39 offset:16384
    ds_read_b64_tr_b16 v[198:199], v39 offset:17408
    s_waitcnt vmcnt(13)
    ds_read_b64_tr_b16 v[200:201], v38 offset:18432
    ds_read_b64_tr_b16 v[202:203], v38 offset:19456
    ds_read_b64_tr_b16 v[204:205], v39 offset:18432
    ds_read_b64_tr_b16 v[206:207], v39 offset:19456
    s_load_dword s6, s[22:23], 0
    s_load_dword s7, s[22:23], 256
    s_load_dword s8, s[22:23], 512
    s_load_dword s9, s[22:23], 768
    s_load_dword s10, s[22:23], 1024
    s_load_dword s11, s[22:23], 1280
    s_load_dword s12, s[22:23], 1536
    s_load_dword s13, s[22:23], 1792
    s_load_dword s14, s[22:23], 2048
    s_load_dword s15, s[22:23], 2304
    s_load_dword s16, s[22:23], 2560
    s_load_dword s17, s[22:23], 2816
    s_load_dword s18, s[22:23], 3072
    s_load_dword s19, s[22:23], 3328
    s_waitcnt lgkmcnt(0)
    s_xor_b32 s6, s6, s52
    s_xor_b32 s7, s7, s52
    s_or_b32 s6, s6, s7
    s_xor_b32 s8, s8, s52
    s_or_b32 s6, s6, s8
    s_xor_b32 s9, s9, s52
    s_or_b32 s6, s6, s9
    s_xor_b32 s10, s10, s52
    s_or_b32 s6, s6, s10
    s_xor_b32 s11, s11, s52
    s_or_b32 s6, s6, s11
    s_xor_b32 s12, s12, s52
    s_or_b32 s6, s6, s12
    s_xor_b32 s13, s13, s52
    s_or_b32 s6, s6, s13
    s_xor_b32 s14, s14, s52
    s_or_b32 s6, s6, s14
    s_xor_b32 s15, s15, s52
    s_or_b32 s6, s6, s15
    s_xor_b32 s16, s16, s52
    s_or_b32 s6, s6, s16
    s_xor_b32 s17, s17, s52
    s_or_b32 s6, s6, s17
    s_xor_b32 s18, s18, s52
    s_or_b32 s6, s6, s18
    s_xor_b32 s19, s19, s52
    s_or_b32 s6, s6, s19
    s_cmp_lg_u32 s6, 0
    s_cbranch_scc1 L_retry_12
L_seen_13:
    v_lshlrev_b32 v8, 4, v1
    v_add_u32 v9, 114688, v8
    s_mov_b32 s67, s63
    s_lshl_b32 s55, s67, 3
    s_mul_i32 s54, s61, 224
    s_add_u32 s54, s54, s55
    s_add_u32 s54, s54, s78
    s_lshl_b32 s66, s54, 10
    s_add_u32 s66, s66, 5242880
    buffer_load_dwordx4 v[80:83], v8, s[36:39], s66 offen sc1
    buffer_load_dwordx4 v[84:87], v9, s[36:39], s66 offen sc1
    s_add_u32 s66, s66, 8192
    s_add_u32 s67, s67, 1
    s_cmp_eq_u32 s67, 14
    s_cselect_b32 s74, 114688, 0
    s_sub_u32 s66, s66, s74
    buffer_load_dwordx4 v[88:91], v8, s[36:39], s66 offen sc1
    buffer_load_dwordx4 v[92:95], v9, s[36:39], s66 offen sc1
    s_add_u32 s66, s66, 8192
    s_add_u32 s67, s67, 1
    s_cmp_eq_u32 s67, 14
    s_cselect_b32 s74, 114688, 0
    s_sub_u32 s66, s66, s74
    buffer_load_dwordx4 v[96:99], v8, s[36:39], s66 offen sc1
    buffer_load_dwordx4 v[100:103], v9, s[36:39], s66 offen sc1
    s_add_u32 s66, s66, 8192
    s_add_u32 s67, s67, 1
    s_cmp_eq_u32 s67, 14
    s_cselect_b32 s74, 114688, 0
    s_sub_u32 s66, s66, s74
    buffer_load_dwordx4 v[104:107], v8, s[36:39], s66 offen sc1
    buffer_load_dwordx4 v[108:111], v9, s[36:39], s66 offen sc1
    s_add_u32 s66, s66, 8192
    s_add_u32 s67, s67, 1
    s_cmp_eq_u32 s67, 14
    s_cselect_b32 s74, 114688, 0
    s_sub_u32 s66, s66, s74
    s_waitcnt vmcnt(18)
    ds_read_b64_tr_b16 v[208:209], v38 offset:32768
    ds_read_b64_tr_b16 v[210:211], v38 offset:33792
    ds_read_b64_tr_b16 v[212:213], v39 offset:32768
    ds_read_b64_tr_b16 v[214:215], v39 offset:33792
    s_waitcnt vmcnt(16)
    ds_read_b64_tr_b16 v[216:217], v38 offset:34816
    ds_read_b64_tr_b16 v[218:219], v38 offset:35840
    ds_read_b64_tr_b16 v[220:221], v39 offset:34816
    ds_read_b64_tr_b16 v[222:223], v39 offset:35840
    s_waitcnt vmcnt(14)
    ds_read_b64_tr_b16 v[224:225], v34 offset:16384
    ds_read_b64_tr_b16 v[226:227], v34 offset:17408
    ds_read_b64_tr_b16 v[228:229], v35 offset:16384
    ds_read_b64_tr_b16 v[230:231], v35 offset:17408
    s_waitcnt vmcnt(12)
    ds_read_b64_tr_b16 v[232:233], v34 offset:18432
    ds_read_b64_tr_b16 v[234:235], v34 offset:19456
    ds_read_b64_tr_b16 v[236:237], v35 offset:18432
    ds_read_b64_tr_b16 v[238:239], v35 offset:19456
    s_waitcnt vmcnt(10)
    ds_read_b64_tr_b16 v[240:241], v34 offset:32768
    ds_read_b64_tr_b16 v[242:243], v34 offset:33792
    ds_read_b64_tr_b16 v[244:245], v35 offset:32768
    ds_read_b64_tr_b16 v[246:247], v35 offset:33792
    s_waitcnt vmcnt(8)
    ds_read_b64_tr_b16 v[248:249], v34 offset:34816
    ds_read_b64_tr_b16 v[250:251], v34 offset:35840
    ds_read_b64_tr_b16 v[252:253], v35 offset:34816
    ds_read_b64_tr_b16 v[254:255], v35 offset:35840
    s_waitcnt lgkmcnt(0)
    v_mov_b32 v13, 21
    ds_write_b32 v10, v13
    s_waitcnt vmcnt(6)
    v_mfma_f32_32x32x16_bf16 v[16:31], v[80:83], v[144:147], 0
    v_mfma_f32_32x32x16_bf16 v[32:47], v[80:83], v[148:151], 0
    buffer_load_dwordx4 v[112:115], v8, s[36:39], s66 offen sc1
    buffer_load_dwordx4 v[116:119], v9, s[36:39], s66 offen sc1
    s_add_u32 s66, s66, 8192
    s_add_u32 s67, s67, 1
    s_cmp_eq_u32 s67, 14
    s_cselect_b32 s74, 114688, 0
    s_sub_u32 s66, s66, s74
    v_mfma_f32_32x32x16_bf16 v[48:63], v[84:87], v[144:147], 0
    v_mfma_f32_32x32x16_bf16 v[64:79], v[84:87], v[148:151], 0
    buffer_load_dwordx4 v[120:123], v8, s[36:39], s66 offen sc1
    buffer_load_dwordx4 v[124:127], v9, s[36:39], s66 offen sc1
    s_add_u32 s66, s66, 8192
    s_add_u32 s67, s67, 1
    s_cmp_eq_u32 s67, 14
    s_cselect_b32 s74, 114688, 0
    s_sub_u32 s66, s66, s74
    s_waitcnt vmcnt(8)
    v_mfma_f32_32x32x16_bf16 v[16:31], v[88:91], v[152:155], v[16:31]
    v_mfma_f32_32x32x16_bf16 v[32:47], v[88:91], v[156:159], v[32:47]
    buffer_load_dwordx4 v[128:131], v8, s[36:39], s66 offen sc1
    buffer_load_dwordx4 v[132:135], v9, s[36:39], s66 offen sc1
    s_add_u32 s66, s66, 8192
    s_add_u32 s67, s67, 1
    s_cmp_eq_u32 s67, 14
    s_cselect_b32 s74, 114688, 0
    s_sub_u32 s66, s66, s74
    v_mfma_f32_32x32x16_bf16 v[48:63], v[92:95], v[152:155], v[48:63]
    v_mfma_f32_32x32x16_bf16 v[64:79], v[92:95], v[156:159], v[64:79]
    buffer_load_dwordx4 v[136:139], v8, s[36:39], s66 offen sc1
    buffer_load_dwordx4 v[140:143], v9, s[36:39], s66 offen sc1
    s_add_u32 s66, s66, 8192
    s_add_u32 s67, s67, 1
    s_cmp_eq_u32 s67, 14
    s_cselect_b32 s74, 114688, 0
    s_sub_u32 s66, s66, s74
    s_waitcnt vmcnt(10)
    v_mfma_f32_32x32x16_bf16 v[16:31], v[96:99], v[160:163], v[16:31]
    v_mfma_f32_32x32x16_bf16 v[32:47], v[96:99], v[164:167], v[32:47]
    buffer_load_dwordx4 v[80:83], v8, s[36:39], s66 offen sc1
    buffer_load_dwordx4 v[84:87], v9, s[36:39], s66 offen sc1
    s_add_u32 s66, s66, 8192
    s_add_u32 s67, s67, 1
    s_cmp_eq_u32 s67, 14
    s_cselect_b32 s74, 114688, 0
    s_sub_u32 s66, s66, s74
    v_mfma_f32_32x32x16_bf16 v[48:63], v[100:103], v[160:163], v[48:63]
    v_mfma_f32_32x32x16_bf16 v[64:79], v[100:103], v[164:167], v[64:79]
    buffer_load_dwordx4 v[88:91], v8, s[36:39], s66 offen sc1
    buffer_load_dwordx4 v[92:95], v9, s[36:39], s66 offen sc1
    s_add_u32 s66, s66, 8192
    s_add_u32 s67, s67, 1
    s_cmp_eq_u32 s67, 14
    s_cselect_b32 s74, 114688, 0
    s_sub_u32 s66, s66, s74
    s_waitcnt vmcnt(12)
    v_mfma_f32_32x32x16_bf16 v[16:31], v[104:107], v[168:171], v[16:31]
    s_mov_b32 s44, s30
    s_mov_b32 s45, s31
    s_mov_b32 s46, 1835008
    s_mov_b32 s47, 0x20000
    v_mfma_f32_32x32x16_bf16 v[32:47], v[104:107], v[172:175], v[32:47]
    buffer_load_dwordx4 v[96:99], v8, s[36:39], s66 offen sc1
    buffer_load_dwordx4 v[100:103], v9, s[36:39], s66 offen sc1
    s_add_u32 s66, s66, 8192
    s_add_u32 s67, s67, 1
    s_cmp_eq_u32 s67, 14
    s_cselect_b32 s74, 114688, 0
    s_sub_u32 s66, s66, s74
    s_lshr_b32 s54, s61, 3
    s_mul_i32 s54, s54, 224
    s_lshl_b32 s55, s62, 5
    s_add_u32 s54, s54, s55
    v_mfma_f32_32x32x16_bf16 v[48:63], v[108:111], v[168:171], v[48:63]
    s_lshl_b32 s55, s53, 3
    s_add_u32 s54, s54, s55
    s_lshl_b32 s54, s54, 7
    s_add_u32 s54, s54, 15073280
    v_mfma_f32_32x32x16_bf16 v[64:79], v[108:111], v[172:175], v[64:79]
    buffer_load_dwordx4 v[104:107], v8, s[36:39], s66 offen sc1
    buffer_load_dwordx4 v[108:111], v9, s[36:39], s66 offen sc1
    s_add_u32 s66, s66, 8192
    s_add_u32 s67, s67, 1
    s_cmp_eq_u32 s67, 14
    s_cselect_b32 s74, 114688, 0
    s_sub_u32 s66, s66, s74
    s_mov_b32 s71, s54
    v_bfe_u32 v161, v1, 1, 3
    v_lshlrev_b32 v161, 8, v161
    v_bfe_u32 v162, v1, 4, 1
    s_waitcnt vmcnt(14)
    v_mfma_f32_32x32x16_bf16 v[16:31], v[112:115], v[176:179], v[16:31]
    v_lshl_add_u32 v161, v162, 7, v161
    v_lshlrev_b32 v160, 7, v162
    v_lshrrev_b32 v162, 5, v1
    v_lshl_add_u32 v161, v162, 6, v161
    v_mfma_f32_32x32x16_bf16 v[32:47], v[112:115], v[180:183], v[32:47]
    v_lshl_add_u32 v160, v162, 13, v160
    v_and_b32 v162, 1, v1
    v_lshl_add_u32 v161, v162, 5, v161
    v_and_b32 v162, 15, v1
    v_mfma_f32_32x32x16_bf16 v[48:63], v[116:119], v[176:179], v[48:63]
    v_lshl_add_u32 v160, v162, 2, v160
    s_lshr_b32 s54, s53, 1
    s_lshl_b32 s54, s54, 12
    s_lshl_b32 s55, s80, 6
    v_mfma_f32_32x32x16_bf16 v[64:79], v[116:119], v[180:183], v[64:79]
    buffer_load_dwordx4 v[112:115], v8, s[36:39], s66 offen sc1
    buffer_load_dwordx4 v[116:119], v9, s[36:39], s66 offen sc1
    s_add_u32 s66, s66, 8192
    s_add_u32 s67, s67, 1
    s_cmp_eq_u32 s67, 14
    s_cselect_b32 s74, 114688, 0
    s_sub_u32 s66, s66, s74
    s_add_u32 s54, s54, s55
    s_add_u32 s54, s54, 147456
    v_add_u32 v160, s54, v160
    s_mul_i32 s54, s61, 224
    s_waitcnt vmcnt(14)
    v_mfma_f32_32x32x16_bf16 v[16:31], v[120:123], v[184:187], v[16:31]
    s_lshl_b32 s55, s62, 5
    s_add_u32 s54, s54, s55
    s_lshl_b32 s55, s53, 3
    s_add_u32 s54, s54, s55
    v_mfma_f32_32x32x16_bf16 v[32:47], v[120:123], v[188:191], v[32:47]
    s_lshl_b32 s54, s54, 8
    s_add_u32 s68, s54, 12582912
    v_bfe_u32 v150, v1, 2, 1
    v_lshrrev_b32 v144, 4, v1
    v_mfma_f32_32x32x16_bf16 v[48:63], v[124:127], v[184:187], v[48:63]
    v_lshl_add_u32 v144, v150, 4, v144
    s_lshr_b32 s54, s3, 2
    s_lshl_b32 s54, s54, 5
    s_lshl_b32 s55, s53, 2
    v_mfma_f32_32x32x16_bf16 v[64:79], v[124:127], v[188:191], v[64:79]
    buffer_load_dwordx4 v[120:123], v8, s[36:39], s66 offen sc1
    buffer_load_dwordx4 v[124:127], v9, s[36:39], s66 offen sc1
    s_add_u32 s54, s54, s55
    v_add_u32 v144, s54, v144
    v_lshlrev_b32 v144, 8, v144
    v_bfe_u32 v145, v1, 3, 1
    s_waitcnt vmcnt(14)
    v_mfma_f32_32x32x16_bf16 v[16:31], v[128:131], v[192:195], v[16:31]
    v_lshl_add_u32 v144, v145, 7, v144
    v_and_b32 v145, 3, v1
    v_lshl_add_u32 v144, v145, 5, v144
    v_lshl_add_u32 v144, v150, 4, v144
    v_mfma_f32_32x32x16_bf16 v[32:47], v[128:131], v[196:199], v[32:47]
    v_xor_b32 v145, 16, v144
    v_add_u32 v146, 0x10000, v144
    v_add_u32 v147, 0x10000, v145
    v_add_u32 v148, 0x20000, v144
    v_mfma_f32_32x32x16_bf16 v[48:63], v[132:135], v[192:195], v[48:63]
    v_add_u32 v149, 0x20000, v145
    v_mul_f32 v3, v3, v3
    v_lshlrev_b32 v152, 16, v4
    v_and_b32 v153, 0xffff0000, v4
    v_mfma_f32_32x32x16_bf16 v[64:79], v[132:135], v[196:199], v[64:79]
    v_lshlrev_b32 v154, 16, v5
    v_and_b32 v155, 0xffff0000, v5
    v_lshlrev_b32 v156, 16, v6
    v_and_b32 v157, 0xffff0000, v6
    s_waitcnt vmcnt(12)
    v_mfma_f32_32x32x16_bf16 v[16:31], v[136:139], v[200:203], v[16:31]
    v_lshlrev_b32 v158, 16, v7
    v_and_b32 v159, 0xffff0000, v7
    v_and_b32 v11, 7, v1
    v_lshlrev_b32 v11, 2, v11
    v_mfma_f32_32x32x16_bf16 v[32:47], v[136:139], v[204:207], v[32:47]
    v_add_u32 v11, 46080, v11
    v_and_b32 v15, 4, v1
    v_cmp_eq_u32 vcc, 0, v15
    v_mov_b32 v15, 7
    v_mfma_f32_32x32x16_bf16 v[48:63], v[140:143], v[200:203], v[48:63]
    v_cndmask_b32_e64 v15, v15, 21, vcc
    s_lshl_b32 s54, s53, 14
    s_add_u32 m0, s54, 81920
    v_mfma_f32_32x32x16_bf16 v[64:79], v[140:143], v[204:207], v[64:79]
    s_waitcnt vmcnt(10)
    v_mfma_f32_32x32x16_bf16 v[16:31], v[80:83], v[208:211], v[16:31]
    v_mfma_f32_32x32x16_bf16 v[32:47], v[80:83], v[212:215], v[32:47]
    v_mfma_f32_32x32x16_bf16 v[48:63], v[84:87], v[208:211], v[48:63]
    v_mfma_f32_32x32x16_bf16 v[64:79], v[84:87], v[212:215], v[64:79]
    s_waitcnt vmcnt(8)
    v_mfma_f32_32x32x16_bf16 v[16:31], v[88:91], v[216:219], v[16:31]
    v_mfma_f32_32x32x16_bf16 v[32:47], v[88:91], v[220:223], v[32:47]
    v_mfma_f32_32x32x16_bf16 v[48:63], v[92:95], v[216:219], v[48:63]
    v_mfma_f32_32x32x16_bf16 v[64:79], v[92:95], v[220:223], v[64:79]
    s_waitcnt vmcnt(6)
    v_mfma_f32_32x32x16_bf16 v[16:31], v[96:99], v[224:227], v[16:31]
    v_mfma_f32_32x32x16_bf16 v[32:47], v[96:99], v[228:231], v[32:47]
    v_mfma_f32_32x32x16_bf16 v[48:63], v[100:103], v[224:227], v[48:63]
    v_mfma_f32_32x32x16_bf16 v[64:79], v[100:103], v[228:231], v[64:79]
    s_waitcnt vmcnt(4)
    v_mfma_f32_32x32x16_bf16 v[16:31], v[104:107], v[232:235], v[16:31]
    v_mfma_f32_32x32x16_bf16 v[32:47], v[104:107], v[236:239], v[32:47]
    v_mfma_f32_32x32x16_bf16 v[48:63], v[108:111], v[232:235], v[48:63]
    v_mfma_f32_32x32x16_bf16 v[64:79], v[108:111], v[236:239], v[64:79]
    s_waitcnt vmcnt(2)
    v_mfma_f32_32x32x16_bf16 v[16:31], v[112:115], v[240:243], v[16:31]
    v_mfma_f32_32x32x16_bf16 v[32:47], v[112:115], v[244:247], v[32:47]
    v_mfma_f32_32x32x16_bf16 v[48:63], v[116:119], v[240:243], v[48:63]
    v_mfma_f32_32x32x16_bf16 v[64:79], v[116:119], v[244:247], v[64:79]
    ds_read_b32 v13, v11
    s_waitcnt vmcnt(0)
    v_mfma_f32_32x32x16_bf16 v[16:31], v[120:123], v[248:251], v[16:31]
    v_mfma_f32_32x32x16_bf16 v[32:47], v[120:123], v[252:255], v[32:47]
    v_mfma_f32_32x32x16_bf16 v[48:63], v[124:127], v[248:251], v[48:63]
    v_mfma_f32_32x32x16_bf16 v[64:79], v[124:127], v[252:255], v[64:79]
    s_waitcnt lgkmcnt(0)
    v_cmp_gt_u32 vcc, v15, v13
    s_cbranch_vccnz L_spin_14
L_sdone_15:
    s_nop 5
    ds_write_addtid_b32 v16 offset:0
    ds_write_addtid_b32 v17 offset:256
    ds_write_addtid_b32 v18 offset:512
    ds_write_addtid_b32 v19 offset:768
    ds_write_addtid_b32 v20 offset:1024
    ds_write_addtid_b32 v21 offset:1280
    ds_write_addtid_b32 v22 offset:1536
    ds_write_addtid_b32 v23 offset:1792
    ds_write_addtid_b32 v24 offset:2048
    ds_write_addtid_b32 v25 offset:2304
    ds_write_addtid_b32 v26 offset:2560
    ds_write_addtid_b32 v27 offset:2816
    ds_write_addtid_b32 v28 offset:3072
    ds_write_addtid_b32 v29 offset:3328
    ds_write_addtid_b32 v30 offset:3584
    ds_write_addtid_b32 v31 offset:3840
    ds_write_addtid_b32 v32 offset:4096
    ds_write_addtid_b32 v33 offset:4352
    ds_write_addtid_b32 v34 offset:4608
    ds_write_addtid_b32 v35 offset:4864
    ds_write_addtid_b32 v36 offset:5120
    ds_write_addtid_b32 v37 offset:5376
    ds_write_addtid_b32 v38 offset:5632
    ds_write_addtid_b32 v39 offset:5888
    ds_write_addtid_b32 v40 offset:6144
    ds_write_addtid_b32 v41 offset:6400
    ds_write_addtid_b32 v42 offset:6656
    ds_write_addtid_b32 v43 offset:6912
    ds_write_addtid_b32 v44 offset:7168
    ds_write_addtid_b32 v45 offset:7424
    ds_write_addtid_b32 v46 offset:7680
    ds_write_addtid_b32 v47 offset:7936
    ds_write_addtid_b32 v48 offset:8192
    ds_write_addtid_b32 v49 offset:8448
    ds_write_addtid_b32 v50 offset:8704
    ds_write_addtid_b32 v51 offset:8960
    ds_write_addtid_b32 v52 offset:9216
    ds_write_addtid_b32 v53 offset:9472
    ds_write_addtid_b32 v54 offset:9728
    ds_write_addtid_b32 v55 offset:9984
    ds_write_addtid_b32 v56 offset:10240
    ds_write_addtid_b32 v57 offset:10496
    ds_write_addtid_b32 v58 offset:10752
    ds_write_addtid_b32 v59 offset:11008
    ds_write_addtid_b32 v60 offset:11264
    ds_write_addtid_b32 v61 offset:11520
    ds_write_addtid_b32 v62 offset:11776
    ds_write_addtid_b32 v63 offset:12032
    ds_write_addtid_b32 v64 offset:12288
    ds_write_addtid_b32 v65 offset:12544
    ds_write_addtid_b32 v66 offset:12800
    ds_write_addtid_b32 v67 offset:13056
    ds_write_addtid_b32 v68 offset:13312
    ds_write_addtid_b32 v69 offset:13568
    ds_write_addtid_b32 v70 offset:13824
    ds_write_addtid_b32 v71 offset:14080
    ds_write_addtid_b32 v72 offset:14336
    ds_write_addtid_b32 v73 offset:14592
    ds_write_addtid_b32 v74 offset:14848
    ds_write_addtid_b32 v75 offset:15104
    ds_write_addtid_b32 v76 offset:15360
    ds_write_addtid_b32 v77 offset:15616
    ds_write_addtid_b32 v78 offset:15872
    ds_write_addtid_b32 v79 offset:16128
    s_mov_b32 s4, s71
    s_add_u32 s22, s34, s71
    s_addc_u32 s23, s35, 0
    s_load_dword s6, s[22:23], 0
    s_load_dword s7, s[22:23], 128
    s_load_dword s8, s[22:23], 256
    s_load_dword s9, s[22:23], 384
    s_load_dword s10, s[22:23], 512
    s_load_dword s11, s[22:23], 640
    s_load_dword s12, s[22:23], 768
    s_load_dword s13, s[22:23], 896
    s_waitcnt lgkmcnt(0)
    s_xor_b32 s6, s6, s52
    s_xor_b32 s7, s7, s52
    s_or_b32 s6, s6, s7
    s_xor_b32 s8, s8, s52
    s_or_b32 s6, s6, s8
    s_xor_b32 s9, s9, s52
    s_or_b32 s6, s6, s9
    s_xor_b32 s10, s10, s52
    s_or_b32 s6, s6, s10
    s_xor_b32 s11, s11, s52
    s_or_b32 s6, s6, s11
    s_xor_b32 s12, s12, s52
    s_or_b32 s6, s6, s12
    s_xor_b32 s13, s13, s52
    s_or_b32 s6, s6, s13
    s_cmp_lg_u32 s6, 0
    s_cbranch_scc1 L_retry_16
L_seen_17:
    buffer_load_dwordx4 v[80:83], v161, s[36:39], s68 offen sc1
    buffer_load_dwordx4 v[84:87], v161, s[36:39], s68 offen offset:16 sc1
    s_waitcnt vmcnt(0)
    v_lshlrev_b32 v88, 16, v80
    v_and_b32 v89, 0xffff0000, v80
    ds_write_b32 v160, v88 offset:0
    ds_write_b32 v160, v89 offset:256
    v_lshlrev_b32 v90, 16, v81
    v_and_b32 v91, 0xffff0000, v81
    ds_write_b32 v160, v90 offset:512
    ds_write_b32 v160, v91 offset:768
    v_lshlrev_b32 v92, 16, v82
    v_and_b32 v93, 0xffff0000, v82
    ds_write_b32 v160, v92 offset:1024
    ds_write_b32 v160, v93 offset:1280
    v_lshlrev_b32 v94, 16, v83
    v_and_b32 v95, 0xffff0000, v83
    ds_write_b32 v160, v94 offset:1536
    ds_write_b32 v160, v95 offset:1792
    v_lshlrev_b32 v96, 16, v84
    v_and_b32 v97, 0xffff0000, v84
    ds_write_b32 v160, v96 offset:2048
    ds_write_b32 v160, v97 offset:2304
    v_lshlrev_b32 v98, 16, v85
    v_and_b32 v99, 0xffff0000, v85
    ds_write_b32 v160, v98 offset:2560
    ds_write_b32 v160, v99 offset:2816
    v_lshlrev_b32 v100, 16, v86
    v_and_b32 v101, 0xffff0000, v86
    ds_write_b32 v160, v100 offset:3072
    ds_write_b32 v160, v101 offset:3328
    v_lshlrev_b32 v102, 16, v87
    v_and_b32 v103, 0xffff0000, v87
    ds_write_b32 v160, v102 offset:3584
    ds_write_b32 v160, v103 offset:3840
    s_branch L_fin
L_S:
    ds_read_b128 v[144:147], v179
    ds_read_b64 v[148:149], v182
    ds_read_b64 v[150:151], v181
    ds_read_b32 v152, v180 offset:2048
    ds_read_b32 v153, v180 offset:2176
    ds_read_b32 v154, v180 offset:2304
    ds_read_b32 v155, v180 offset:2432
    s_waitcnt lgkmcnt(0)
    v_add_f32 v160, v160, v144
    v_add_f32 v161, v161, v145
    v_add_f32 v162, v162, v146
    v_add_f32 v163, v163, v147
    v_add_f32 v164, v164, v148
    v_add_f32 v165, v165, v149
    v_add_f32 v166, v166, v150
    v_add_f32 v167, v167, v151
    v_add_f32 v168, v168, v152
    v_add_f32 v169, v169, v153
    v_add_f32 v170, v170, v154
    v_add_f32 v171, v171, v155
    ds_write_b128 v179, v[160:163]
    ds_write_b64 v182, v[164:165]
    ds_write_b64 v181, v[166:167]
    ds_write_b32 v180, v168 offset:2048
    s_mov_b32 exec_hi, 0
    ds_write_b32 v180, v169 offset:2176
    ds_write_b32 v180, v170 offset:2304
    ds_write_b32 v180, v171 offset:2432
    s_mov_b64 exec, -1
    s_add_u32 m0, s70, 0
    s_nop 0
    buffer_load_dwordx4 v200, s[40:43], s66 offen offset:0 lds
    buffer_load_dwordx4 v201, s[40:43], s66 offen offset:1024 lds
    buffer_load_dwordx4 v202, s[40:43], s66 offen offset:2048 lds
    buffer_load_dwordx4 v203, s[40:43], s66 offen offset:3072 lds
    s_add_u32 s66, s66, 128
    s_add_u32 s67, s67, 1
    s_cmp_eq_u32 s67, 7
    s_cselect_b32 s66, s71, s66
    s_add_u32 m0, s70, 16384
    s_nop 0
    buffer_load_dwordx4 v204, s[24:27], s68 offen offset:0 lds
    buffer_load_dwordx4 v205, s[24:27], s68 offen offset:1024 lds
    buffer_load_dwordx4 v206, s[24:27], s68 offen offset:2048 lds
    buffer_load_dwordx4 v207, s[24:27], s68 offen offset:3072 lds
    s_add_u32 s68, s68, 114688
    s_add_u32 s69, s69, 1
    s_cmp_eq_u32 s69, 14
    s_cselect_b32 s74, 1605632, 0
    s_sub_u32 s68, s68, s74
    v_mov_b32 v104, v200
    v_mov_b32 v105, v201
    v_mov_b32 v106, v202
    v_mov_b32 v107, v203
    v_mov_b32 v108, v204
    v_mov_b32 v109, v205
    v_mov_b32 v110, v206
    v_mov_b32 v111, v207
    s_lshl_b32 s78, s80, 2
    s_lshr_b32 s54, s53, 1
    s_add_u32 s78, s78, s54
    s_add_u32 s78, s78, 2
    v_mov_b32 v38, v186
    v_mov_b32 v39, v187
    s_waitcnt vmcnt(8)
    s_waitcnt lgkmcnt(0)
    s_barrier
    ds_read_b64_tr_b16 v[144:145], v38 offset:0
    ds_read_b64_tr_b16 v[146:147], v38 offset:1024
    ds_read_b64_tr_b16 v[148:149], v39 offset:0
    ds_read_b64_tr_b16 v[150:151], v39 offset:1024
    ds_read_b64_tr_b16 v[152:153], v38 offset:10752
    ds_read_b64_tr_b16 v[154:155], v38 offset:11776
    ds_read_b64_tr_b16 v[156:157], v39 offset:10752
    ds_read_b64_tr_b16 v[158:159], v39 offset:11776
    s_add_u32 m0, s70, 49152
    s_nop 0
    buffer_load_dwordx4 v108, s[24:27], s68 offen offset:0 lds
    s_lshl_b32 s54, s80, 10
    s_sub_u32 s54, 2047, s54
    buffer_load_dwordx4 v109, s[24:27], s68 offen offset:1024 lds
    v_lshlrev_b32 v16, 1, v1
    v_sub_u32 v16, s54, v16
    buffer_load_dwordx4 v110, s[24:27], s68 offen offset:2048 lds
    v_cvt_f32_u32 v17, v16
    s_sub_u32 s83, s82, 68096
    buffer_load_dwordx4 v111, s[24:27], s68 offen offset:3072 lds
    s_add_u32 s68, s68, 114688
    s_add_u32 s69, s69, 1
    s_cmp_eq_u32 s69, 14
    s_cselect_b32 s74, 1605632, 0
    s_sub_u32 s68, s68, s74
    v_add_f32 v18, -1.0, v17
    v_cvt_pk_bf16_f32 v18, v17, v18
    s_add_u32 m0, s70, 32768
    s_nop 0
    buffer_load_dwordx4 v104, s[40:43], s66 offen offset:0 lds
    v_and_b32 v20, 0xffff, v18
    v_lshrrev_b32 v21, 16, v18
    buffer_load_dwordx4 v105, s[40:43], s66 offen offset:1024 lds
    v_lshl_add_u32 v20, v20, 2, s83
    v_lshl_add_u32 v21, v21, 2, s83
    buffer_load_dwordx4 v106, s[40:43], s66 offen offset:2048 lds
    v_add_f32 v17, 0xc3000000, v17
    s_add_u32 s54, s82, 2048
    buffer_load_dwordx4 v107, s[40:43], s66 offen offset:3072 lds
    s_add_u32 s66, s66, 128
    s_add_u32 s67, s67, 1
    s_cmp_eq_u32 s67, 7
    s_cselect_b32 s66, s71, s66
    v_mov_b32 v19, s54
    ds_read2st64_b32 v[112:113], v19 offset0:0 offset1:11
    ds_read2st64_b32 v[40:41], v20 offset0:0 offset1:11
    ds_read2st64_b32 v[42:43], v21 offset0:0 offset1:11
    s_waitcnt lgkmcnt(0)
    v_add_f32 v112, v112, v113
    v_cvt_pk_bf16_f32 v19, v112, v112
    v_add_f32 v40, v40, v41
    v_add_f32 v42, v42, v43
    v_cvt_pk_bf16_f32 v40, v40, v42
    s_nop 1
    v_mov_b32_dpp v19, v40 wave_shr:1 row_mask:0xf bank_mask:0xf
    v_alignbit_b32 v41, v40, v19, 16
    s_waitcnt vmcnt(8)
    s_waitcnt lgkmcnt(0)
    s_barrier
    ds_read_b64_tr_b16 v[160:161], v38 offset:2048
    ds_read_b64_tr_b16 v[162:163], v38 offset:3072
    ds_read_b64_tr_b16 v[164:165], v39 offset:2048
    ds_read_b64_tr_b16 v[166:167], v39 offset:3072
    s_add_u32 m0, s70, 81920
    s_nop 0
    buffer_load_dwordx4 v108, s[24:27], s68 offen offset:0 lds
    v_add_f32 v18, -1.0, v17
    v_cvt_pk_bf16_f32 v18, v17, v18
    v_and_b32 v22, 0xffff, v18
    v_lshrrev_b32 v23, 16, v18
    v_lshl_add_u32 v22, v22, 2, s83
    v_lshl_add_u32 v23, v23, 2, s83
    buffer_load_dwordx4 v109, s[24:27], s68 offen offset:1024 lds
    v_add_f32 v17, 0xc3000000, v17
    v_add_f32 v18, -1.0, v17
    v_cvt_pk_bf16_f32 v18, v17, v18
    v_and_b32 v24, 0xffff, v18
    v_lshrrev_b32 v25, 16, v18
    v_lshl_add_u32 v24, v24, 2, s83
    buffer_load_dwordx4 v110, s[24:27], s68 offen offset:2048 lds
    v_lshl_add_u32 v25, v25, 2, s83
    v_add_f32 v17, 0xc3000000, v17
    ds_read2st64_b32 v[48:49], v22 offset0:0 offset1:11
    ds_read2st64_b32 v[50:51], v23 offset0:0 offset1:11
    ds_read2st64_b32 v[56:57], v24 offset0:0 offset1:11
    ds_read2st64_b32 v[58:59], v25 offset0:0 offset1:11
    buffer_load_dwordx4 v111, s[24:27], s68 offen offset:3072 lds
    s_add_u32 s68, s68, 114688
    s_add_u32 s69, s69, 1
    s_cmp_eq_u32 s69, 14
    s_cselect_b32 s74, 1605632, 0
    s_sub_u32 s68, s68, s74
    s_waitcnt lgkmcnt(2)
    v_mov_b32_dpp v19, v40 wave_ror:1 row_mask:0xf bank_mask:0xf
    v_add_f32 v48, v48, v49
    v_add_f32 v50, v50, v51
    v_cvt_pk_bf16_f32 v48, v48, v50
    s_nop 1
    v_mov_b32_dpp v19, v48 wave_shr:1 row_mask:0xf bank_mask:0xf
    v_alignbit_b32 v49, v48, v19, 16
    s_waitcnt lgkmcnt(0)
    v_mov_b32_dpp v19, v48 wave_ror:1 row_mask:0xf bank_mask:0xf
    v_add_f32 v56, v56, v57
    v_add_f32 v58, v58, v59
    v_cvt_pk_bf16_f32 v56, v56, v58
    s_nop 1
    v_mov_b32_dpp v19, v56 wave_shr:1 row_mask:0xf bank_mask:0xf
    v_alignbit_b32 v57, v56, v19, 16
    s_waitcnt vmcnt(8)
    s_waitcnt lgkmcnt(0)
    s_barrier
    ds_read_b64_tr_b16 v[168:169], v38 offset:8704
    ds_read_b64_tr_b16 v[170:171], v38 offset:9728
    ds_read_b64_tr_b16 v[172:173], v39 offset:8704
    ds_read_b64_tr_b16 v[174:175], v39 offset:9728
    s_add_u32 m0, s70, 98304
    s_nop 0
    buffer_load_dwordx4 v108, s[24:27], s68 offen offset:0 lds
    v_add_f32 v18, -1.0, v17
    buffer_load_dwordx4 v109, s[24:27], s68 offen offset:1024 lds
    v_cvt_pk_bf16_f32 v18, v17, v18
    buffer_load_dwordx4 v110, s[24:27], s68 offen offset:2048 lds
    v_and_b32 v26, 0xffff, v18
    buffer_load_dwordx4 v111, s[24:27], s68 offen offset:3072 lds
    s_add_u32 s68, s68, 114688
    s_add_u32 s69, s69, 1
    s_cmp_eq_u32 s69, 14
    s_cselect_b32 s74, 1605632, 0
    s_sub_u32 s68, s68, s74
    v_lshrrev_b32 v27, 16, v18
    s_add_u32 m0, s70, 65536
    s_nop 0
    buffer_load_dwordx4 v104, s[40:43], s66 offen offset:0 lds
    v_lshl_add_u32 v26, v26, 2, s83
    buffer_load_dwordx4 v105, s[40:43], s66 offen offset:1024 lds
    v_lshl_add_u32 v27, v27, 2, s83
    buffer_load_dwordx4 v106, s[40:43], s66 offen offset:2048 lds
    v_add_f32 v17, 0xc3000000, v17
    buffer_load_dwordx4 v107, s[40:43], s66 offen offset:3072 lds
    s_add_u32 s66, s66, 128
    s_add_u32 s67, s67, 1
    s_cmp_eq_u32 s67, 7
    s_cselect_b32 s66, s71, s66
    ds_read2st64_b32 v[64:65], v26 offset0:0 offset1:11
    ds_read2st64_b32 v[66:67], v27 offset0:0 offset1:11
    s_waitcnt lgkmcnt(0)
    v_mov_b32_dpp v19, v56 wave_ror:1 row_mask:0xf bank_mask:0xf
    v_add_f32 v64, v64, v65
    v_add_f32 v66, v66, v67
    v_cvt_pk_bf16_f32 v64, v64, v66
    s_nop 1
    v_mov_b32_dpp v19, v64 wave_shr:1 row_mask:0xf bank_mask:0xf
    v_alignbit_b32 v65, v64, v19, 16
    s_waitcnt vmcnt(8)
    s_waitcnt lgkmcnt(0)
    s_barrier
    ds_read_b64_tr_b16 v[176:177], v38 offset:0
    ds_read_b64_tr_b16 v[178:179], v38 offset:1024
    ds_read_b64_tr_b16 v[180:181], v39 offset:0
    ds_read_b64_tr_b16 v[182:183], v39 offset:1024
    ds_read_b64_tr_b16 v[184:185], v38 offset:10752
    ds_read_b64_tr_b16 v[186:187], v38 offset:11776
    ds_read_b64_tr_b16 v[188:189], v39 offset:10752
    ds_read_b64_tr_b16 v[190:191], v39 offset:11776
    s_add_u32 m0, s70, 16384
    s_nop 0
    buffer_load_dwordx4 v108, s[24:27], s68 offen offset:0 lds
    v_add_f32 v18, -1.0, v17
    v_cvt_pk_bf16_f32 v18, v17, v18
    v_and_b32 v28, 0xffff, v18
    v_lshrrev_b32 v29, 16, v18
    v_lshl_add_u32 v28, v28, 2, s83
    v_lshl_add_u32 v29, v29, 2, s83
    buffer_load_dwordx4 v109, s[24:27], s68 offen offset:1024 lds
    v_add_f32 v17, 0xc3000000, v17
    v_add_f32 v18, -1.0, v17
    v_cvt_pk_bf16_f32 v18, v17, v18
    v_and_b32 v30, 0xffff, v18
    v_lshrrev_b32 v31, 16, v18
    v_lshl_add_u32 v30, v30, 2, s83
    buffer_load_dwordx4 v110, s[24:27], s68 offen offset:2048 lds
    v_lshl_add_u32 v31, v31, 2, s83
    v_add_f32 v17, 0xc3000000, v17
    ds_read2st64_b32 v[72:73], v28 offset0:0 offset1:11
    ds_read2st64_b32 v[74:75], v29 offset0:0 offset1:11
    ds_read2st64_b32 v[80:81], v30 offset0:0 offset1:11
    ds_read2st64_b32 v[82:83], v31 offset0:0 offset1:11
    buffer_load_dwordx4 v111, s[24:27], s68 offen offset:3072 lds
    s_add_u32 s68, s68, 114688
    s_add_u32 s69, s69, 1
    s_cmp_eq_u32 s69, 14
    s_cselect_b32 s74, 1605632, 0
    s_sub_u32 s68, s68, s74
    s_waitcnt lgkmcnt(2)
    v_mov_b32_dpp v19, v64 wave_ror:1 row_mask:0xf bank_mask:0xf
    v_add_f32 v72, v72, v73
    v_add_f32 v74, v74, v75
    v_cvt_pk_bf16_f32 v72, v72, v74
    s_nop 1
    v_mov_b32_dpp v19, v72 wave_shr:1 row_mask:0xf bank_mask:0xf
    v_alignbit_b32 v73, v72, v19, 16
    s_waitcnt lgkmcnt(0)
    v_mov_b32_dpp v19, v72 wave_ror:1 row_mask:0xf bank_mask:0xf
    v_add_f32 v80, v80, v81
    v_add_f32 v82, v82, v83
    v_cvt_pk_bf16_f32 v80, v80, v82
    s_nop 1
    v_mov_b32_dpp v19, v80 wave_shr:1 row_mask:0xf bank_mask:0xf
    v_alignbit_b32 v81, v80, v19, 16
    s_waitcnt vmcnt(8)
    s_waitcnt lgkmcnt(0)
    s_barrier
    ds_read_b64_tr_b16 v[192:193], v38 offset:2048
    ds_read_b64_tr_b16 v[194:195], v38 offset:3072
    ds_read_b64_tr_b16 v[196:197], v39 offset:2048
    ds_read_b64_tr_b16 v[198:199], v39 offset:3072
    s_load_dword s52, s[32:33], 0
    s_add_u32 m0, s70, 49152
    s_nop 0
    buffer_load_dwordx4 v108, s[24:27], s68 offen offset:0 lds
    v_add_f32 v18, -1.0, v17
    buffer_load_dwordx4 v109, s[24:27], s68 offen offset:1024 lds
    v_cvt_pk_bf16_f32 v18, v17, v18
    buffer_load_dwordx4 v110, s[24:27], s68 offen offset:2048 lds
    v_and_b32 v32, 0xffff, v18
    buffer_load_dwordx4 v111, s[24:27], s68 offen offset:3072 lds
    s_add_u32 s68, s68, 114688
    s_add_u32 s69, s69, 1
    s_cmp_eq_u32 s69, 14
    s_cselect_b32 s74, 1605632, 0
    s_sub_u32 s68, s68, s74
    v_lshrrev_b32 v33, 16, v18
    s_add_u32 m0, s70, 0
    s_nop 0
    buffer_load_dwordx4 v104, s[40:43], s66 offen offset:0 lds
    v_lshl_add_u32 v32, v32, 2, s83
    buffer_load_dwordx4 v105, s[40:43], s66 offen offset:1024 lds
    v_lshl_add_u32 v33, v33, 2, s83
    buffer_load_dwordx4 v106, s[40:43], s66 offen offset:2048 lds
    v_add_f32 v17, 0xc3000000, v17
    buffer_load_dwordx4 v107, s[40:43], s66 offen offset:3072 lds
    s_add_u32 s66, s66, 128
    s_add_u32 s67, s67, 1
    s_cmp_eq_u32 s67, 7
    s_cselect_b32 s66, s71, s66
    ds_read2st64_b32 v[88:89], v32 offset0:0 offset1:11
    ds_read2st64_b32 v[90:91], v33 offset0:0 offset1:11
    s_waitcnt lgkmcnt(0)
    v_mov_b32_dpp v19, v80 wave_ror:1 row_mask:0xf bank_mask:0xf
    v_add_f32 v88, v88, v89
    v_add_f32 v90, v90, v91
    v_cvt_pk_bf16_f32 v88, v88, v90
    s_nop 1
    v_mov_b32_dpp v19, v88 wave_shr:1 row_mask:0xf bank_mask:0xf
    v_alignbit_b32 v89, v88, v19, 16
    s_waitcnt lgkmcnt(0)
    s_cmp_eq_u32 s52, 0
    s_cbranch_scc1 L_nonce_18
L_ndone_19:
    s_waitcnt vmcnt(8)
    s_waitcnt lgkmcnt(0)
    s_barrier
    ds_read_b64_tr_b16 v[200:201], v38 offset:8704
    ds_read_b64_tr_b16 v[202:203], v38 offset:9728
    ds_read_b64_tr_b16 v[204:205], v39 offset:8704
    ds_read_b64_tr_b16 v[206:207], v39 offset:9728
    s_add_u32 m0, s70, 81920
    s_nop 0
    buffer_load_dwordx4 v108, s[24:27], s68 offen offset:0 lds
    v_add_f32 v18, -1.0, v17
    v_cvt_pk_bf16_f32 v18, v17, v18
    v_and_b32 v34, 0xffff, v18
    v_lshrrev_b32 v35, 16, v18
    v_lshl_add_u32 v34, v34, 2, s83
    buffer_load_dwordx4 v109, s[24:27], s68 offen offset:1024 lds
    v_lshl_add_u32 v35, v35, 2, s83
    v_add_u32 v16, 4294966400, v16
    v_min_u32 v18, 128, v16
    v_lshl_add_u32 v18, v18, 2, s82
    v_max_i32 v34, v34, v18
    buffer_load_dwordx4 v110, s[24:27], s68 offen offset:2048 lds
    v_add_u32 v16, -1, v16
    v_min_u32 v18, 128, v16
    v_lshl_add_u32 v18, v18, 2, s82
    v_max_i32 v35, v35, v18
    ds_read2st64_b32 v[96:97], v34 offset0:0 offset1:11
    buffer_load_dwordx4 v111, s[24:27], s68 offen offset:3072 lds
    s_add_u32 s68, s68, 114688
    s_add_u32 s69, s69, 1
    s_cmp_eq_u32 s69, 14
    s_cselect_b32 s74, 1605632, 0
    s_sub_u32 s68, s68, s74
    ds_read2st64_b32 v[98:99], v35 offset0:0 offset1:11
    s_waitcnt lgkmcnt(0)
    v_mov_b32_dpp v19, v88 wave_ror:1 row_mask:0xf bank_mask:0xf
    v_add_f32 v96, v96, v97
    v_add_f32 v98, v98, v99
    v_cvt_pk_bf16_f32 v96, v96, v98
    s_nop 1
    v_mov_b32_dpp v19, v96 wave_shr:1 row_mask:0xf bank_mask:0xf
    v_alignbit_b32 v97, v96, v19, 16
    v_mov_b32 v42, 0
    v_mov_b32 v43, 0
    v_readlane_b32 s54, v96, 63
    s_nop 0
    s_lshr_b32 s54, s54, 16
    v_writelane_b32 v43, s54, 0
    s_waitcnt vmcnt(8)
    s_waitcnt lgkmcnt(0)
    s_barrier
    ds_read_b64_tr_b16 v[208:209], v38 offset:0
    ds_read_b64_tr_b16 v[210:211], v38 offset:1024
    ds_read_b64_tr_b16 v[212:213], v39 offset:0
    ds_read_b64_tr_b16 v[214:215], v39 offset:1024
    ds_read_b64_tr_b16 v[216:217], v38 offset:10752
    ds_read_b64_tr_b16 v[218:219], v38 offset:11776
    ds_read_b64_tr_b16 v[220:221], v39 offset:10752
    ds_read_b64_tr_b16 v[222:223], v39 offset:11776
    s_add_u32 m0, s70, 98304
    s_nop 0
    buffer_load_dwordx4 v108, s[24:27], s68 offen offset:0 lds
    v_and_b32 v6, 31, v1
    v_lshrrev_b32 v7, 5, v1
    buffer_load_dwordx4 v109, s[24:27], s68 offen offset:1024 lds
    v_add_u32 v2, 1, v6
    v_and_b32 v4, 3, v2
    buffer_load_dwordx4 v110, s[24:27], s68 offen offset:2048 lds
    v_lshrrev_b32 v2, 2, v2
    v_lshlrev_b32 v2, 3, v2
    buffer_load_dwordx4 v111, s[24:27], s68 offen offset:3072 lds
    s_add_u32 s68, s68, 114688
    s_add_u32 s69, s69, 1
    s_cmp_eq_u32 s69, 14
    s_cselect_b32 s74, 1605632, 0
    s_sub_u32 s68, s68, s74
    v_lshlrev_b32 v3, 4, v7
    v_sub_u32 v2, v3, v2
    s_add_u32 m0, s70, 32768
    s_nop 0
    buffer_load_dwordx4 v104, s[40:43], s66 offen offset:0 lds
    v_mul_u32_u24 v5, 4160, v4
    v_cmp_eq_u32 vcc, 0, v4
    buffer_load_dwordx4 v105, s[40:43], s66 offen offset:1024 lds
    v_add_u32 v5, 256, v5
    v_cndmask_b32_e64 v5, v5, 8, vcc
    buffer_load_dwordx4 v106, s[40:43], s66 offen offset:2048 lds
    v_add_u32 v2, v2, v5
    s_lshl_b32 s54, s80, 5
    buffer_load_dwordx4 v107, s[40:43], s66 offen offset:3072 lds
    s_add_u32 s55, s54, s81
    s_add_u32 s55, s55, 64
    v_add_u32 v2, s55, v2
    s_add_u32 s54, s54, s82
    v_add_u32 v4, s54, v3
    v_mul_u32_u24 v3, 80, v6
    v_add_u32 v5, 80, v3
    v_add_u32 v5, v4, v5
    v_add_u32 v3, -2480, v5
    s_waitcnt vmcnt(8)
    s_waitcnt lgkmcnt(0)
    s_barrier
    ds_read_b64_tr_b16 v[224:225], v38 offset:2048
    ds_read_b64_tr_b16 v[226:227], v38 offset:3072
    ds_read_b64_tr_b16 v[228:229], v39 offset:2048
    ds_read_b64_tr_b16 v[230:231], v39 offset:3072
    s_lshl_b32 s54, s53, 10
    s_add_u32 s54, s54, 14680064
    s_mov_b32 s4, s54
    s_add_u32 s22, s34, s54
    s_addc_u32 s23, s35, 0
    s_load_dword s6, s[22:23], 0
    s_load_dword s7, s[22:23], 128
    s_load_dword s8, s[22:23], 256
    s_load_dword s9, s[22:23], 384
    s_load_dword s10, s[22:23], 512
    s_load_dword s11, s[22:23], 640
    s_load_dword s12, s[22:23], 768
    s_load_dword s13, s[22:23], 896
    s_add_u32 m0, s70, 16384
    s_nop 0
    buffer_load_dwordx4 v108, s[24:27], s68 offen offset:0 lds
    v_lshlrev_b32 v122, 4, v1
    s_lshl_b32 s54, s79, 12
    s_lshl_b32 s55, s80, 11
    buffer_load_dwordx4 v109, s[24:27], s68 offen offset:1024 lds
    s_add_u32 s54, s54, s55
    s_add_u32 s83, s54, 1048576
    v_lshrrev_b32 v123, 2, v1
    buffer_load_dwordx4 v110, s[24:27], s68 offen offset:2048 lds
    v_mul_u32_u24 v123, 80, v123
    v_and_b32 v136, 3, v1
    v_lshl_add_u32 v123, v136, 4, v123
    buffer_load_dwordx4 v111, s[24:27], s68 offen offset:3072 lds
    s_add_u32 s68, s68, 114688
    s_add_u32 s69, s69, 1
    s_cmp_eq_u32 s69, 14
    s_cselect_b32 s74, 1605632, 0
    s_sub_u32 s68, s68, s74
    s_mul_i32 s54, s80, 2560
    s_add_u32 s54, s54, s82
    v_add_u32 v123, s54, v123
    v_and_b32 v136, 3, v1
    v_lshl_add_u32 v136, v136, 4, s82
    v_mov_b32 v140, 0
    v_mov_b32 v141, 0
    v_mov_b32 v142, 0
    v_mov_b32 v143, 0
    s_waitcnt lgkmcnt(0)
    s_xor_b32 s6, s6, s52
    s_xor_b32 s7, s7, s52
    s_or_b32 s6, s6, s7
    s_xor_b32 s8, s8, s52
    s_or_b32 s6, s6, s8
    s_xor_b32 s9, s9, s52
    s_or_b32 s6, s6, s9
    s_xor_b32 s10, s10, s52
    s_or_b32 s6, s6, s10
    s_xor_b32 s11, s11, s52
    s_or_b32 s6, s6, s11
    s_xor_b32 s12, s12, s52
    s_or_b32 s6, s6, s12
    s_xor_b32 s13, s13, s52
    s_or_b32 s6, s6, s13
    s_cmp_lg_u32 s6, 0
    s_cbranch_scc1 L_retry_20
L_seen_21:
    s_waitcnt vmcnt(8)
    s_waitcnt lgkmcnt(0)
    s_barrier
    ds_read_b64_tr_b16 v[232:233], v38 offset:8704
    ds_read_b64_tr_b16 v[234:235], v38 offset:9728
    ds_read_b64_tr_b16 v[236:237], v39 offset:8704
    ds_read_b64_tr_b16 v[238:239], v39 offset:9728
    s_add_u32 m0, s70, 49152
    s_nop 0
    buffer_load_dwordx4 v108, s[24:27], s68 offen offset:0 lds
    buffer_load_dwordx4 v109, s[24:27], s68 offen offset:1024 lds
    buffer_load_dwordx4 v110, s[24:27], s68 offen offset:2048 lds
    buffer_load_dwordx4 v111, s[24:27], s68 offen offset:3072 lds
    s_add_u32 s68, s68, 114688
    s_add_u32 s69, s69, 1
    s_cmp_eq_u32 s69, 14
    s_cselect_b32 s74, 1605632, 0
    s_sub_u32 s68, s68, s74
    s_add_u32 m0, s70, 65536
    s_nop 0
    buffer_load_dwordx4 v108, s[24:27], s68 offen offset:0 lds
    buffer_load_dwordx4 v109, s[24:27], s68 offen offset:1024 lds
    buffer_load_dwordx4 v110, s[24:27], s68 offen offset:2048 lds
    buffer_load_dwordx4 v111, s[24:27], s68 offen offset:3072 lds
    s_waitcnt vmcnt(8)
    s_waitcnt lgkmcnt(0)
    s_barrier
    ds_read_b64_tr_b16 v[240:241], v38 offset:0
    ds_read_b64_tr_b16 v[242:243], v38 offset:1024
    ds_read_b64_tr_b16 v[244:245], v39 offset:0
    ds_read_b64_tr_b16 v[246:247], v39 offset:1024
    ds_read_b64_tr_b16 v[248:249], v38 offset:10752
    ds_read_b64_tr_b16 v[250:251], v38 offset:11776
    ds_read_b64_tr_b16 v[252:253], v39 offset:10752
    ds_read_b64_tr_b16 v[254:255], v39 offset:11776
    s_lshl_b32 s54, s60, 8
    s_add_u32 s54, s54, 14684160
    s_mov_b32 s4, s54
    s_add_u32 s22, s34, s54
    s_addc_u32 s23, s35, 0
    s_load_dword s6, s[22:23], 0
    s_load_dword s7, s[22:23], 128
    buffer_load_dwordx4 v[128:131], v122, s[36:39], s83 offen sc1
    buffer_load_dwordx4 v[132:135], v122, s[36:39], s83 offen offset:1024 sc1
    v_bfe_u32 v82, v1, 3, 1
    v_lshrrev_b32 v83, 4, v1
    v_lshl_add_u32 v83, v82, 2, v83
    v_mul_u32_u24 v82, 896, v83
    v_and_b32 v84, 7, v1
    v_lshl_add_u32 v82, v84, 4, v82
    v_lshlrev_b32 v83, 3, v83
    s_lshl_b32 s54, s61, 3
    s_add_u32 s54, s54, s3
    s_lshl_b32 s56, s54, 6
    s_add_u32 s56, s56, 32768
    s_mul_i32 s54, s54, 7168
    s_lshl_b32 s55, s62, 7
    s_add_u32 s85, s54, s55
    buffer_load_dwordx4 v[84:87], v82, s[40:43], s85 offen
    buffer_load_dword v83, v83, s[36:39], s56 offen offset:4 sc1
    s_waitcnt lgkmcnt(0)
    s_xor_b32 s6, s6, s52
    s_xor_b32 s7, s7, s52
    s_or_b32 s6, s6, s7
    s_cmp_lg_u32 s6, 0
    s_cbranch_scc1 L_retry_22
L_seen_23:
    s_waitcnt vmcnt(4)
    s_waitcnt lgkmcnt(0)
    s_barrier
    s_lshl_b32 s54, s80, 11
    s_add_u32 s54, s54, s81
    s_add_u32 m0, s54, 8
    s_nop 0
    ds_write_addtid_b32 v40 offset:0
    ds_write_addtid_b32 v48 offset:256
    ds_write_addtid_b32 v56 offset:512
    ds_write_addtid_b32 v64 offset:768
    ds_write_addtid_b32 v72 offset:1024
    ds_write_addtid_b32 v80 offset:1280
    ds_write_addtid_b32 v88 offset:1536
    ds_write_addtid_b32 v96 offset:1792
    s_add_u32 m0, s54, 4416
    s_nop 0
    ds_write_addtid_b32 v41 offset:0
    ds_write_addtid_b32 v49 offset:256
    ds_write_addtid_b32 v57 offset:512
    ds_write_addtid_b32 v65 offset:768
    ds_write_addtid_b32 v73 offset:1024
    ds_write_addtid_b32 v81 offset:1280
    ds_write_addtid_b32 v89 offset:1536
    ds_write_addtid_b32 v97 offset:1792
    s_add_u32 m0, s54, 8580
    s_nop 0
    ds_write_addtid_b32 v40 offset:0
    ds_write_addtid_b32 v48 offset:256
    ds_write_addtid_b32 v56 offset:512
    ds_write_addtid_b32 v64 offset:768
    ds_write_addtid_b32 v72 offset:1024
    ds_write_addtid_b32 v80 offset:1280
    ds_write_addtid_b32 v88 offset:1536
    ds_write_addtid_b32 v96 offset:1792
    s_add_u32 m0, s54, 12740
    s_nop 0
    ds_write_addtid_b32 v41 offset:0
    ds_write_addtid_b32 v49 offset:256
    ds_write_addtid_b32 v57 offset:512
    ds_write_addtid_b32 v65 offset:768
    ds_write_addtid_b32 v73 offset:1024
    ds_write_addtid_b32 v81 offset:1280
    ds_write_addtid_b32 v89 offset:1536
    ds_write_addtid_b32 v97 offset:1792
    s_cmp_eq_u32 s80, 0
    s_cbranch_scc1 L_nt_24
    s_mov_b64 exec, 0xffff
    s_add_u32 m0, s54, 8
    s_nop 0
    ds_write_addtid_b32 v42 offset:2048
    s_add_u32 m0, s54, 4416
    s_nop 0
    ds_write_addtid_b32 v43 offset:2048
    s_add_u32 m0, s54, 8580
    s_nop 0
    ds_write_addtid_b32 v42 offset:2048
    s_add_u32 m0, s54, 12740
    s_nop 0
    ds_write_addtid_b32 v43 offset:2048
    s_mov_b64 exec, -1
L_nt_24:
    ds_write_b128 v136, v[140:143]
    s_waitcnt vmcnt(2)
    ds_write_b128 v123, v[128:131] offset:80
    ds_write_b128 v123, v[132:135] offset:1360
    v_and_b32 v11, 3, v1
    v_lshlrev_b32 v11, 2, v11
    v_add_u32 v11, 46096, v11
    v_bfe_u32 v48, v1, 1, 1
    v_mul_u32_u24 v48, 16704, v48
    v_and_b32 v49, 1, v1
    v_mul_u32_u24 v49, 2080, v49
    v_add_u32 v48, v48, v49
    v_bfe_u32 v49, v1, 2, 3
    v_lshl_add_u32 v49, v7, 5, v49
    v_lshl_add_u32 v48, v49, 2, v48
    s_lshr_b32 s54, s53, 1
    s_mul_i32 s54, s54, 4160
    s_lshl_b32 s55, s80, 6
    s_add_u32 s54, s54, s55
    v_add_u32 v48, s54, v48
    v_add_u32 v49, 1040, v48
    v_add_u32 v50, 8352, v48
    v_add_u32 v51, 9392, v48
    v_add_u32 v52, 32, v48
    v_add_u32 v53, 1072, v48
    v_add_u32 v54, 8384, v48
    v_add_u32 v55, 9424, v48
    v_bfe_u32 v59, v1, 3, 2
    v_mul_u32_u24 v59, 57344, v59
    v_lshl_add_u32 v59, v7, 7, v59
    v_and_b32 v60, 7, v1
    v_lshl_add_u32 v59, v60, 4, v59
    s_mul_i32 s54, s53, 458752
    s_lshl_b32 s55, s64, 8
    s_add_u32 s54, s54, s55
    s_add_u32 s68, s54, 12582912
    s_add_u32 s70, s68, 229376
    s_mul_i32 s54, s53, 224
    s_add_u32 s54, s54, s64
    s_lshl_b32 s54, s54, 7
    s_add_u32 s69, s54, 15073280
    s_lshl_b32 s54, s61, 12
    s_lshl_b32 s55, s80, 7
    s_add_u32 s54, s54, s55
    s_add_u32 s54, s54, 14942208
    s_mov_b32 s4, s54
    s_add_u32 s22, s34, s54
    s_addc_u32 s23, s35, 0
    s_mul_i32 s75, s53, 8352
    s_waitcnt lgkmcnt(0)
    s_barrier
    s_setprio 1
    ds_read_b64 v[96:97], v2 offset:4032
    ds_read_b64 v[98:99], v2 offset:4040
    ds_read_b128 v[108:111], v3 offset:5040
    ds_read_b128 v[104:107], v5
    ds_read_b64 v[100:101], v2 offset:1984
    ds_read_b64 v[102:103], v2 offset:1992
    v_add_u32 v5, -80, v5
    v_max_i32 v5, v5, v4
    ds_read_b64 v[112:113], v2 offset:3968
    ds_read_b64 v[114:115], v2 offset:3976
    ds_read_b128 v[124:127], v3 offset:4960
    ds_read_b128 v[120:123], v5
    ds_read_b64 v[116:117], v2 offset:1920
    ds_read_b64 v[118:119], v2 offset:1928
    v_add_u32 v5, -80, v5
    v_max_i32 v5, v5, v4
    s_waitcnt lgkmcnt(6)
    v_mfma_f32_32x32x16_bf16 v[32:47], v[96:99], v[108:111], 0
    ds_read_b64 v[128:129], v2 offset:3904
    ds_read_b64 v[130:131], v2 offset:3912
    v_mfma_f32_32x32x16_bf16 v[16:31], v[96:99], v[104:107], 0
    ds_read_b128 v[140:143], v3 offset:4880
    ds_read_b128 v[136:139], v5
    v_mfma_f32_32x32x16_bf16 v[32:47], v[100:103], v[104:107], v[32:47]
    ds_read_b64 v[132:133], v2 offset:1856
    ds_read_b64 v[134:135], v2 offset:1864
    v_add_u32 v5, -80, v5
    v_max_i32 v5, v5, v4
    s_waitcnt lgkmcnt(6)
    v_mfma_f32_32x32x16_bf16 v[32:47], v[112:115], v[124:127], v[32:47]
    ds_read_b64 v[96:97], v2 offset:3840
    ds_read_b64 v[98:99], v2 offset:3848
    v_mfma_f32_32x32x16_bf16 v[16:31], v[112:115], v[120:123], v[16:31]
    ds_read_b128 v[108:111], v3 offset:4800
    ds_read_b128 v[104:107], v5
    v_mfma_f32_32x32x16_bf16 v[32:47], v[116:119], v[120:123], v[32:47]
    ds_read_b64 v[100:101], v2 offset:1792
    ds_read_b64 v[102:103], v2 offset:1800
    v_add_u32 v5, -80, v5
    v_max_i32 v5, v5, v4
    s_waitcnt lgkmcnt(6)
    v_mfma_f32_32x32x16_bf16 v[32:47], v[128:131], v[140:143], v[32:47]
    ds_read_b64 v[112:113], v2 offset:3776
    ds_read_b64 v[114:115], v2 offset:3784
    v_mfma_f32_32x32x16_bf16 v[16:31], v[128:131], v[136:139], v[16:31]
    ds_read_b128 v[124:127], v3 offset:4720
    ds_read_b128 v[120:123], v5
    v_mfma_f32_32x32x16_bf16 v[32:47], v[132:135], v[136:139], v[32:47]
    ds_read_b64 v[116:117], v2 offset:1728
    ds_read_b64 v[118:119], v2 offset:1736
    v_add_u32 v5, -80, v5
    v_max_i32 v5, v5, v4
    s_waitcnt lgkmcnt(6)
    v_mfma_f32_32x32x16_bf16 v[32:47], v[96:99], v[108:111], v[32:47]
    ds_read_b64 v[128:129], v2 offset:3712
    ds_read_b64 v[130:131], v2 offset:3720
    v_mfma_f32_32x32x16_bf16 v[16:31], v[96:99], v[104:107], v[16:31]
    ds_read_b128 v[140:143], v3 offset:4640
    ds_read_b128 v[136:139], v5
    v_mfma_f32_32x32x16_bf16 v[32:47], v[100:103], v[104:107], v[32:47]
    ds_read_b64 v[132:133], v2 offset:1664
    ds_read_b64 v[134:135], v2 offset:1672
    v_add_u32 v5, -80, v5
    v_max_i32 v5, v5, v4
    s_waitcnt lgkmcnt(6)
    v_mfma_f32_32x32x16_bf16 v[32:47], v[112:115], v[124:127], v[32:47]
    ds_read_b64 v[96:97], v2 offset:3648
    ds_read_b64 v[98:99], v2 offset:3656
    v_mfma_f32_32x32x16_bf16 v[16:31], v[112:115], v[120:123], v[16:31]
    ds_read_b128 v[108:111], v3 offset:4560
    ds_read_b128 v[104:107], v5
    v_mfma_f32_32x32x16_bf16 v[32:47], v[116:119], v[120:123], v[32:47]
    ds_read_b64 v[100:101], v2 offset:1600
    ds_read_b64 v[102:103], v2 offset:1608
    v_add_u32 v5, -80, v5
    v_max_i32 v5, v5, v4
    s_waitcnt lgkmcnt(6)
    v_mfma_f32_32x32x16_bf16 v[32:47], v[128:131], v[140:143], v[32:47]
    ds_read_b64 v[112:113], v2 offset:3584
    ds_read_b64 v[114:115], v2 offset:3592
    v_mfma_f32_32x32x16_bf16 v[16:31], v[128:131], v[136:139], v[16:31]
    ds_read_b128 v[124:127], v3 offset:4480
    ds_read_b128 v[120:123], v5
    v_mfma_f32_32x32x16_bf16 v[32:47], v[132:135], v[136:139], v[32:47]
    ds_read_b64 v[116:117], v2 offset:1536
    ds_read_b64 v[118:119], v2 offset:1544
    v_add_u32 v5, -80, v5
    v_max_i32 v5, v5, v4
    s_waitcnt lgkmcnt(6)
    v_mfma_f32_32x32x16_bf16 v[32:47], v[96:99], v[108:111], v[32:47]
    ds_read_b64 v[128:129], v2 offset:3520
    ds_read_b64 v[130:131], v2 offset:3528
    v_mfma_f32_32x32x16_bf16 v[16:31], v[96:99], v[104:107], v[16:31]
    ds_read_b128 v[140:143], v3 offset:4400
    ds_read_b128 v[136:139], v5
    v_mfma_f32_32x32x16_bf16 v[32:47], v[100:103], v[104:107], v[32:47]
    ds_read_b64 v[132:133], v2 offset:1472
    ds_read_b64 v[134:135], v2 offset:1480
    v_add_u32 v5, -80, v5
    v_max_i32 v5, v5, v4
    s_waitcnt lgkmcnt(6)
    v_mfma_f32_32x32x16_bf16 v[32:47], v[112:115], v[124:127], v[32:47]
    ds_read_b64 v[96:97], v2 offset:3456
    ds_read_b64 v[98:99], v2 offset:3464
    v_mfma_f32_32x32x16_bf16 v[16:31], v[112:115], v[120:123], v[16:31]
    ds_read_b128 v[108:111], v3 offset:4320
    ds_read_b128 v[104:107], v5
    v_mfma_f32_32x32x16_bf16 v[32:47], v[116:119], v[120:123], v[32:47]
    ds_read_b64 v[100:101], v2 offset:1408
    ds_read_b64 v[102:103], v2 offset:1416
    v_add_u32 v5, -80, v5
    v_max_i32 v5, v5, v4
    s_waitcnt lgkmcnt(6)
    v_mfma_f32_32x32x16_bf16 v[32:47], v[128:131], v[140:143], v[32:47]
    ds_read_b64 v[112:113], v2 offset:3392
    ds_read_b64 v[114:115], v2 offset:3400
    v_mfma_f32_32x32x16_bf16 v[16:31], v[128:131], v[136:139], v[16:31]
    ds_read_b128 v[124:127], v3 offset:4240
    ds_read_b128 v[120:123], v5
    v_mfma_f32_32x32x16_bf16 v[32:47], v[132:135], v[136:139], v[32:47]
    ds_read_b64 v[116:117], v2 offset:1344
    ds_read_b64 v[118:119], v2 offset:1352
    v_add_u32 v5, -80, v5
    v_max_i32 v5, v5, v4
    s_waitcnt lgkmcnt(6)
    v_mfma_f32_32x32x16_bf16 v[32:47], v[96:99], v[108:111], v[32:47]
    ds_read_b64 v[128:129], v2 offset:3328
    ds_read_b64 v[130:131], v2 offset:3336
    v_mfma_f32_32x32x16_bf16 v[16:31], v[96:99], v[104:107], v[16:31]
    ds_read_b128 v[140:143], v3 offset:4160
    ds_read_b128 v[136:139], v5
    v_mfma_f32_32x32x16_bf16 v[32:47], v[100:103], v[104:107], v[32:47]
    ds_read_b64 v[132:133], v2 offset:1280
    ds_read_b64 v[134:135], v2 offset:1288
    v_add_u32 v5, -80, v5
    v_max_i32 v5, v5, v4
    s_waitcnt lgkmcnt(6)
    v_mfma_f32_32x32x16_bf16 v[32:47], v[112:115], v[124:127], v[32:47]
    ds_read_b64 v[96:97], v2 offset:3264
    ds_read_b64 v[98:99], v2 offset:3272
    v_mfma_f32_32x32x16_bf16 v[16:31], v[112:115], v[120:123], v[16:31]
    ds_read_b128 v[108:111], v3 offset:4080
    ds_read_b128 v[104:107], v5
    v_mfma_f32_32x32x16_bf16 v[32:47], v[116:119], v[120:123], v[32:47]
    ds_read_b64 v[100:101], v2 offset:1216
    ds_read_b64 v[102:103], v2 offset:1224
    v_add_u32 v5, -80, v5
    v_max_i32 v5, v5, v4
    s_waitcnt lgkmcnt(6)
    v_mfma_f32_32x32x16_bf16 v[32:47], v[128:131], v[140:143], v[32:47]
    ds_read_b64 v[112:113], v2 offset:3200
    ds_read_b64 v[114:115], v2 offset:3208
    v_mfma_f32_32x32x16_bf16 v[16:31], v[128:131], v[136:139], v[16:31]
    ds_read_b128 v[124:127], v3 offset:4000
    ds_read_b128 v[120:123], v5
    v_mfma_f32_32x32x16_bf16 v[32:47], v[132:135], v[136:139], v[32:47]
    ds_read_b64 v[116:117], v2 offset:1152
    ds_read_b64 v[118:119], v2 offset:1160
    v_add_u32 v5, -80, v5
    v_max_i32 v5, v5, v4
    s_waitcnt lgkmcnt(6)
    v_mfma_f32_32x32x16_bf16 v[32:47], v[96:99], v[108:111], v[32:47]
    ds_read_b64 v[128:129], v2 offset:3136
    ds_read_b64 v[130:131], v2 offset:3144
    v_mfma_f32_32x32x16_bf16 v[16:31], v[96:99], v[104:107], v[16:31]
    ds_read_b128 v[140:143], v3 offset:3920
    ds_read_b128 v[136:139], v5
    v_mfma_f32_32x32x16_bf16 v[32:47], v[100:103], v[104:107], v[32:47]
    ds_read_b64 v[132:133], v2 offset:1088
    ds_read_b64 v[134:135], v2 offset:1096
    v_add_u32 v5, -80, v5
    v_max_i32 v5, v5, v4
    s_waitcnt lgkmcnt(6)
    v_mfma_f32_32x32x16_bf16 v[32:47], v[112:115], v[124:127], v[32:47]
    ds_read_b64 v[96:97], v2 offset:3072
    ds_read_b64 v[98:99], v2 offset:3080
    v_mfma_f32_32x32x16_bf16 v[16:31], v[112:115], v[120:123], v[16:31]
    ds_read_b128 v[108:111], v3 offset:3840
    ds_read_b128 v[104:107], v5
    v_mfma_f32_32x32x16_bf16 v[32:47], v[116:119], v[120:123], v[32:47]
    ds_read_b64 v[100:101], v2 offset:1024
    ds_read_b64 v[102:103], v2 offset:1032
    v_add_u32 v5, -80, v5
    v_max_i32 v5, v5, v4
    s_waitcnt lgkmcnt(6)
    v_mfma_f32_32x32x16_bf16 v[32:47], v[128:131], v[140:143], v[32:47]
    ds_read_b64 v[112:113], v2 offset:3008
    ds_read_b64 v[114:115], v2 offset:3016
    v_mfma_f32_32x32x16_bf16 v[16:31], v[128:131], v[136:139], v[16:31]
    ds_read_b128 v[124:127], v3 offset:3760
    ds_read_b128 v[120:123], v5
    v_mfma_f32_32x32x16_bf16 v[32:47], v[132:135], v[136:139], v[32:47]
    ds_read_b64 v[116:117], v2 offset:960
    ds_read_b64 v[118:119], v2 offset:968
    v_add_u32 v5, -80, v5
    v_max_i32 v5, v5, v4
    s_waitcnt lgkmcnt(6)
    v_mfma_f32_32x32x16_bf16 v[32:47], v[96:99], v[108:111], v[32:47]
    ds_read_b64 v[128:129], v2 offset:2944
    ds_read_b64 v[130:131], v2 offset:2952
    v_mfma_f32_32x32x16_bf16 v[16:31], v[96:99], v[104:107], v[16:31]
    ds_read_b128 v[140:143], v3 offset:3680
    ds_read_b128 v[136:139], v5
    v_mfma_f32_32x32x16_bf16 v[32:47], v[100:103], v[104:107], v[32:47]
    ds_read_b64 v[132:133], v2 offset:896
    ds_read_b64 v[134:135], v2 offset:904
    v_add_u32 v5, -80, v5
    v_max_i32 v5, v5, v4
    s_waitcnt lgkmcnt(6)
    v_mfma_f32_32x32x16_bf16 v[32:47], v[112:115], v[124:127], v[32:47]
    ds_read_b64 v[96:97], v2 offset:2880
    ds_read_b64 v[98:99], v2 offset:2888
    v_mfma_f32_32x32x16_bf16 v[16:31], v[112:115], v[120:123], v[16:31]
    ds_read_b128 v[108:111], v3 offset:3600
    ds_read_b128 v[104:107], v5
    v_mfma_f32_32x32x16_bf16 v[32:47], v[116:119], v[120:123], v[32:47]
    ds_read_b64 v[100:101], v2 offset:832
    ds_read_b64 v[102:103], v2 offset:840
    v_add_u32 v5, -80, v5
    v_max_i32 v5, v5, v4
    s_waitcnt lgkmcnt(6)
    v_mfma_f32_32x32x16_bf16 v[32:47], v[128:131], v[140:143], v[32:47]
    ds_read_b64 v[112:113], v2 offset:2816
    ds_read_b64 v[114:115], v2 offset:2824
    v_mfma_f32_32x32x16_bf16 v[16:31], v[128:131], v[136:139], v[16:31]
    ds_read_b128 v[124:127], v3 offset:3520
    ds_read_b128 v[120:123], v5
    v_mfma_f32_32x32x16_bf16 v[32:47], v[132:135], v[136:139], v[32:47]
    ds_read_b64 v[116:117], v2 offset:768
    ds_read_b64 v[118:119], v2 offset:776
    v_add_u32 v5, -80, v5
    v_max_i32 v5, v5, v4
    s_waitcnt lgkmcnt(6)
    v_mfma_f32_32x32x16_bf16 v[32:47], v[96:99], v[108:111], v[32:47]
    ds_read_b64 v[128:129], v2 offset:2752
    ds_read_b64 v[130:131], v2 offset:2760
    v_mfma_f32_32x32x16_bf16 v[16:31], v[96:99], v[104:107], v[16:31]
    ds_read_b128 v[140:143], v3 offset:3440
    ds_read_b128 v[136:139], v5
    v_mfma_f32_32x32x16_bf16 v[32:47], v[100:103], v[104:107], v[32:47]
    ds_read_b64 v[132:133], v2 offset:704
    ds_read_b64 v[134:135], v2 offset:712
    v_add_u32 v5, -80, v5
    v_max_i32 v5, v5, v4
    s_waitcnt lgkmcnt(6)
    v_mfma_f32_32x32x16_bf16 v[32:47], v[112:115], v[124:127], v[32:47]
    ds_read_b64 v[96:97], v2 offset:2688
    ds_read_b64 v[98:99], v2 offset:2696
    v_mfma_f32_32x32x16_bf16 v[16:31], v[112:115], v[120:123], v[16:31]
    ds_read_b128 v[108:111], v3 offset:3360
    ds_read_b128 v[104:107], v5
    v_mfma_f32_32x32x16_bf16 v[32:47], v[116:119], v[120:123], v[32:47]
    ds_read_b64 v[100:101], v2 offset:640
    ds_read_b64 v[102:103], v2 offset:648
    v_add_u32 v5, -80, v5
    v_max_i32 v5, v5, v4
    s_waitcnt lgkmcnt(6)
    v_mfma_f32_32x32x16_bf16 v[32:47], v[128:131], v[140:143], v[32:47]
    ds_read_b64 v[112:113], v2 offset:2624
    ds_read_b64 v[114:115], v2 offset:2632
    v_mfma_f32_32x32x16_bf16 v[16:31], v[128:131], v[136:139], v[16:31]
    ds_read_b128 v[124:127], v3 offset:3280
    ds_read_b128 v[120:123], v5
    v_mfma_f32_32x32x16_bf16 v[32:47], v[132:135], v[136:139], v[32:47]
    ds_read_b64 v[116:117], v2 offset:576
    ds_read_b64 v[118:119], v2 offset:584
    v_add_u32 v5, -80, v5
    v_max_i32 v5, v5, v4
    s_waitcnt lgkmcnt(6)
    v_mfma_f32_32x32x16_bf16 v[32:47], v[96:99], v[108:111], v[32:47]
    ds_read_b64 v[128:129], v2 offset:2560
    ds_read_b64 v[130:131], v2 offset:2568
    v_mfma_f32_32x32x16_bf16 v[16:31], v[96:99], v[104:107], v[16:31]
    ds_read_b128 v[140:143], v3 offset:3200
    ds_read_b128 v[136:139], v5
    v_mfma_f32_32x32x16_bf16 v[32:47], v[100:103], v[104:107], v[32:47]
    ds_read_b64 v[132:133], v2 offset:512
    ds_read_b64 v[134:135], v2 offset:520
    v_add_u32 v5, -80, v5
    v_max_i32 v5, v5, v4
    s_waitcnt lgkmcnt(6)
    v_mfma_f32_32x32x16_bf16 v[32:47], v[112:115], v[124:127], v[32:47]
    ds_read_b64 v[96:97], v2 offset:2496
    ds_read_b64 v[98:99], v2 offset:2504
    v_mfma_f32_32x32x16_bf16 v[16:31], v[112:115], v[120:123], v[16:31]
    ds_read_b128 v[108:111], v3 offset:3120
    ds_read_b128 v[104:107], v5
    v_mfma_f32_32x32x16_bf16 v[32:47], v[116:119], v[120:123], v[32:47]
    ds_read_b64 v[100:101], v2 offset:448
    ds_read_b64 v[102:103], v2 offset:456
    v_add_u32 v5, -80, v5
    v_max_i32 v5, v5, v4
    s_waitcnt lgkmcnt(6)
    v_mfma_f32_32x32x16_bf16 v[32:47], v[128:131], v[140:143], v[32:47]
    ds_read_b64 v[112:113], v2 offset:2432
    ds_read_b64 v[114:115], v2 offset:2440
    v_mfma_f32_32x32x16_bf16 v[16:31], v[128:131], v[136:139], v[16:31]
    ds_read_b128 v[124:127], v3 offset:3040
    ds_read_b128 v[120:123], v5
    v_mfma_f32_32x32x16_bf16 v[32:47], v[132:135], v[136:139], v[32:47]
    ds_read_b64 v[116:117], v2 offset:384
    ds_read_b64 v[118:119], v2 offset:392
    v_add_u32 v5, -80, v5
    v_max_i32 v5, v5, v4
    s_waitcnt lgkmcnt(6)
    v_mfma_f32_32x32x16_bf16 v[32:47], v[96:99], v[108:111], v[32:47]
    ds_read_b64 v[128:129], v2 offset:2368
    ds_read_b64 v[130:131], v2 offset:2376
    v_mfma_f32_32x32x16_bf16 v[16:31], v[96:99], v[104:107], v[16:31]
    ds_read_b128 v[140:143], v3 offset:2960
    ds_read_b128 v[136:139], v5
    v_mfma_f32_32x32x16_bf16 v[32:47], v[100:103], v[104:107], v[32:47]
    ds_read_b64 v[132:133], v2 offset:320
    ds_read_b64 v[134:135], v2 offset:328
    v_add_u32 v5, -80, v5
    v_max_i32 v5, v5, v4
    s_waitcnt lgkmcnt(6)
    v_mfma_f32_32x32x16_bf16 v[32:47], v[112:115], v[124:127], v[32:47]
    ds_read_b64 v[96:97], v2 offset:2304
    ds_read_b64 v[98:99], v2 offset:2312
    v_mfma_f32_32x32x16_bf16 v[16:31], v[112:115], v[120:123], v[16:31]
    ds_read_b128 v[108:111], v3 offset:2880
    ds_read_b128 v[104:107], v5
    v_mfma_f32_32x32x16_bf16 v[32:47], v[116:119], v[120:123], v[32:47]
    ds_read_b64 v[100:101], v2 offset:256
    ds_read_b64 v[102:103], v2 offset:264
    v_add_u32 v5, -80, v5
    v_max_i32 v5, v5, v4
    s_waitcnt lgkmcnt(6)
    v_mfma_f32_32x32x16_bf16 v[32:47], v[128:131], v[140:143], v[32:47]
    ds_read_b64 v[112:113], v2 offset:2240
    ds_read_b64 v[114:115], v2 offset:2248
    v_mfma_f32_32x32x16_bf16 v[16:31], v[128:131], v[136:139], v[16:31]
    ds_read_b128 v[124:127], v3 offset:2800
    ds_read_b128 v[120:123], v5
    v_mfma_f32_32x32x16_bf16 v[32:47], v[132:135], v[136:139], v[32:47]
    ds_read_b64 v[116:117], v2 offset:192
    ds_read_b64 v[118:119], v2 offset:200
    v_add_u32 v5, -80, v5
    v_max_i32 v5, v5, v4
    s_waitcnt lgkmcnt(6)
    v_mfma_f32_32x32x16_bf16 v[32:47], v[96:99], v[108:111], v[32:47]
    ds_read_b64 v[128:129], v2 offset:2176
    ds_read_b64 v[130:131], v2 offset:2184
    v_mfma_f32_32x32x16_bf16 v[16:31], v[96:99], v[104:107], v[16:31]
    ds_read_b128 v[140:143], v3 offset:2720
    ds_read_b128 v[136:139], v5
    v_mfma_f32_32x32x16_bf16 v[32:47], v[100:103], v[104:107], v[32:47]
    ds_read_b64 v[132:133], v2 offset:128
    ds_read_b64 v[134:135], v2 offset:136
    v_add_u32 v5, -80, v5
    v_max_i32 v5, v5, v4
    s_waitcnt lgkmcnt(6)
    v_mfma_f32_32x32x16_bf16 v[32:47], v[112:115], v[124:127], v[32:47]
    ds_read_b64 v[96:97], v2 offset:2112
    ds_read_b64 v[98:99], v2 offset:2120
    v_mfma_f32_32x32x16_bf16 v[16:31], v[112:115], v[120:123], v[16:31]
    ds_read_b128 v[108:111], v3 offset:2640
    ds_read_b128 v[104:107], v5
    v_mfma_f32_32x32x16_bf16 v[32:47], v[116:119], v[120:123], v[32:47]
    ds_read_b64 v[100:101], v2 offset:64
    ds_read_b64 v[102:103], v2 offset:72
    v_add_u32 v5, -80, v5
    v_max_i32 v5, v5, v4
    s_waitcnt lgkmcnt(6)
    v_mfma_f32_32x32x16_bf16 v[32:47], v[128:131], v[140:143], v[32:47]
    ds_read_b64 v[112:113], v2 offset:2048
    ds_read_b64 v[114:115], v2 offset:2056
    v_mfma_f32_32x32x16_bf16 v[16:31], v[128:131], v[136:139], v[16:31]
    ds_read_b128 v[124:127], v3 offset:2560
    ds_read_b128 v[120:123], v5
    v_mfma_f32_32x32x16_bf16 v[32:47], v[132:135], v[136:139], v[32:47]
    ds_read_b64 v[116:117], v2 offset:0
    ds_read_b64 v[118:119], v2 offset:8
    v_add_u32 v5, -80, v5
    v_max_i32 v5, v5, v4
    s_waitcnt lgkmcnt(6)
    v_mfma_f32_32x32x16_bf16 v[32:47], v[96:99], v[108:111], v[32:47]
    v_mfma_f32_32x32x16_bf16 v[16:31], v[96:99], v[104:107], v[16:31]
    v_mfma_f32_32x32x16_bf16 v[32:47], v[100:103], v[104:107], v[32:47]
    v_mov_b32 v12, 5
    ds_write_b32 v10, v12
    s_waitcnt lgkmcnt(1)
    v_mfma_f32_32x32x16_bf16 v[32:47], v[112:115], v[124:127], v[32:47]
    v_mfma_f32_32x32x16_bf16 v[16:31], v[112:115], v[120:123], v[16:31]
    v_mfma_f32_32x32x16_bf16 v[32:47], v[116:119], v[120:123], v[32:47]
    v_mov_b32 v2, v82
    v_mov_b32 v3, v83
    v_mov_b32 v4, v84
    v_mov_b32 v5, v85
    v_mov_b32 v6, v86
    v_mov_b32 v7, v87
    ds_read_b32 v13, v11
    s_waitcnt lgkmcnt(0)
    v_cmp_gt_u32 vcc, 5, v13
    s_cbranch_vccnz L_spin_25
L_sdone_26:
    s_mov_b32 m0, s75
    s_nop 0
    ds_write_addtid_b32 v16 offset:0
    ds_write_addtid_b32 v17 offset:260
    ds_write_addtid_b32 v18 offset:520
    ds_write_addtid_b32 v19 offset:780
    ds_write_addtid_b32 v20 offset:1040
    ds_write_addtid_b32 v21 offset:1300
    ds_write_addtid_b32 v22 offset:1560
    ds_write_addtid_b32 v23 offset:1820
    ds_write_addtid_b32 v24 offset:2080
    ds_write_addtid_b32 v25 offset:2340
    ds_write_addtid_b32 v26 offset:2600
    ds_write_addtid_b32 v27 offset:2860
    ds_write_addtid_b32 v28 offset:3120
    ds_write_addtid_b32 v29 offset:3380
    ds_write_addtid_b32 v30 offset:3640
    ds_write_addtid_b32 v31 offset:3900
    ds_write_addtid_b32 v32 offset:4160
    ds_write_addtid_b32 v33 offset:4420
    ds_write_addtid_b32 v34 offset:4680
    ds_write_addtid_b32 v35 offset:4940
    ds_write_addtid_b32 v36 offset:5200
    ds_write_addtid_b32 v37 offset:5460
    ds_write_addtid_b32 v38 offset:5720
    ds_write_addtid_b32 v39 offset:5980
    ds_write_addtid_b32 v40 offset:6240
    ds_write_addtid_b32 v41 offset:6500
    ds_write_addtid_b32 v42 offset:6760
    ds_write_addtid_b32 v43 offset:7020
    ds_write_addtid_b32 v44 offset:7280
    ds_write_addtid_b32 v45 offset:7540
    ds_write_addtid_b32 v46 offset:7800
    ds_write_addtid_b32 v47 offset:8060
    v_mov_b32 v12, 6
    ds_write_b32 v10, v12
    s_load_dword s6, s[22:23], 0
    s_load_dword s7, s[22:23], 256
    s_load_dword s8, s[22:23], 512
    s_load_dword s9, s[22:23], 768
    s_load_dword s10, s[22:23], 1024
    s_load_dword s11, s[22:23], 1280
    s_load_dword s12, s[22:23], 1536
    s_load_dword s13, s[22:23], 1792
    s_load_dword s14, s[22:23], 2048
    s_load_dword s15, s[22:23], 2304
    s_load_dword s16, s[22:23], 2560
    s_load_dword s17, s[22:23], 2816
    s_load_dword s18, s[22:23], 3072
    s_load_dword s19, s[22:23], 3328
    ds_read_b32 v13, v11
    s_waitcnt lgkmcnt(0)
    v_cmp_gt_u32 vcc, 6, v13
    s_cbranch_vccnz L_spin_27
L_sdone_28:
    ds_read2_b32 v[16:17], v48 offset0:0 offset1:65
    ds_read2_b32 v[18:19], v48 offset0:130 offset1:195
    ds_read2_b32 v[20:21], v49 offset0:0 offset1:65
    ds_read2_b32 v[22:23], v49 offset0:130 offset1:195
    ds_read2_b32 v[24:25], v50 offset0:0 offset1:65
    ds_read2_b32 v[26:27], v50 offset0:130 offset1:195
    ds_read2_b32 v[28:29], v51 offset0:0 offset1:65
    ds_read2_b32 v[30:31], v51 offset0:130 offset1:195
    ds_read2_b32 v[32:33], v52 offset0:0 offset1:65
    ds_read2_b32 v[34:35], v52 offset0:130 offset1:195
    ds_read2_b32 v[36:37], v53 offset0:0 offset1:65
    ds_read2_b32 v[38:39], v53 offset0:130 offset1:195
    ds_read2_b32 v[40:41], v54 offset0:0 offset1:65
    ds_read2_b32 v[42:43], v54 offset0:130 offset1:195
    ds_read2_b32 v[44:45], v55 offset0:0 offset1:65
    ds_read2_b32 v[46:47], v55 offset0:130 offset1:195
    s_waitcnt lgkmcnt(8)
    v_add_f32 v16, v16, v24
    v_add_f32 v17, v17, v25
    v_add_f32 v18, v18, v26
    v_add_f32 v19, v19, v27
    v_add_f32 v20, v20, v28
    v_add_f32 v21, v21, v29
    v_add_f32 v22, v22, v30
    v_add_f32 v23, v23, v31
    v_cvt_pk_bf16_f32 v64, v16, v17
    v_cvt_pk_bf16_f32 v65, v18, v19
    v_cvt_pk_bf16_f32 v66, v20, v21
    v_cvt_pk_bf16_f32 v67, v22, v23
    buffer_store_dwordx4 v[64:67], v59, s[36:39], s68 offen sc1
    s_waitcnt lgkmcnt(0)
    v_mov_b32 v12, 7
    ds_write_b32 v10, v12
    v_add_f32 v32, v32, v40
    v_add_f32 v33, v33, v41
    v_add_f32 v34, v34, v42
    v_add_f32 v35, v35, v43
    v_add_f32 v36, v36, v44
    v_add_f32 v37, v37, v45
    v_add_f32 v38, v38, v46
    v_add_f32 v39, v39, v47
    v_cvt_pk_bf16_f32 v68, v32, v33
    v_cvt_pk_bf16_f32 v69, v34, v35
    v_cvt_pk_bf16_f32 v70, v36, v37
    v_cvt_pk_bf16_f32 v71, v38, v39
    buffer_store_dwordx4 v[68:71], v59, s[36:39], s70 offen sc1
    s_mov_b32 s70, s85
    s_waitcnt lgkmcnt(0)
    s_xor_b32 s6, s6, s52
    s_xor_b32 s7, s7, s52
    s_or_b32 s6, s6, s7
    s_xor_b32 s8, s8, s52
    s_or_b32 s6, s6, s8
    s_xor_b32 s9, s9, s52
    s_or_b32 s6, s6, s9
    s_xor_b32 s10, s10, s52
    s_or_b32 s6, s6, s10
    s_xor_b32 s11, s11, s52
    s_or_b32 s6, s6, s11
    s_xor_b32 s12, s12, s52
    s_or_b32 s6, s6, s12
    s_xor_b32 s13, s13, s52
    s_or_b32 s6, s6, s13
    s_xor_b32 s14, s14, s52
    s_or_b32 s6, s6, s14
    s_xor_b32 s15, s15, s52
    s_or_b32 s6, s6, s15
    s_xor_b32 s16, s16, s52
    s_or_b32 s6, s6, s16
    s_xor_b32 s17, s17, s52
    s_or_b32 s6, s6, s17
    s_xor_b32 s18, s18, s52
    s_or_b32 s6, s6, s18
    s_xor_b32 s19, s19, s52
    s_or_b32 s6, s6, s19
    s_cmp_lg_u32 s6, 0
    s_cbranch_scc1 L_retry_29
L_seen_30:
    v_lshlrev_b32 v8, 4, v1
    v_add_u32 v9, 114688, v8
    s_mov_b32 s67, s63
    s_lshl_b32 s55, s67, 3
    s_mul_i32 s54, s61, 224
    s_add_u32 s54, s54, s55
    s_add_u32 s54, s54, s78
    s_lshl_b32 s66, s54, 10
    s_add_u32 s66, s66, 5242880
    buffer_load_dwordx4 v[80:83], v8, s[36:39], s66 offen sc1
    buffer_load_dwordx4 v[84:87], v9, s[36:39], s66 offen sc1
    s_add_u32 s66, s66, 8192
    s_add_u32 s67, s67, 1
    s_cmp_eq_u32 s67, 14
    s_cselect_b32 s74, 114688, 0
    s_sub_u32 s66, s66, s74
    buffer_load_dwordx4 v[88:91], v8, s[36:39], s66 offen sc1
    buffer_load_dwordx4 v[92:95], v9, s[36:39], s66 offen sc1
    s_add_u32 s66, s66, 8192
    s_add_u32 s67, s67, 1
    s_cmp_eq_u32 s67, 14
    s_cselect_b32 s74, 114688, 0
    s_sub_u32 s66, s66, s74
    buffer_load_dwordx4 v[96:99], v8, s[36:39], s66 offen sc1
    buffer_load_dwordx4 v[100:103], v9, s[36:39], s66 offen sc1
    s_add_u32 s66, s66, 8192
    s_add_u32 s67, s67, 1
    s_cmp_eq_u32 s67, 14
    s_cselect_b32 s74, 114688, 0
    s_sub_u32 s66, s66, s74
    buffer_load_dwordx4 v[104:107], v8, s[36:39], s66 offen sc1
    buffer_load_dwordx4 v[108:111], v9, s[36:39], s66 offen sc1
    s_add_u32 s66, s66, 8192
    s_add_u32 s67, s67, 1
    s_cmp_eq_u32 s67, 14
    s_cselect_b32 s74, 114688, 0
    s_sub_u32 s66, s66, s74
    s_waitcnt vmcnt(8)
    v_mov_b32 v14, s52
    v_lshlrev_b32 v15, 19, v1
    s_mov_b64 exec, 15
    buffer_store_dword v14, v15, s[36:39], s69 offen sc1
    s_mov_b64 exec, -1
    s_setprio 0
    s_waitcnt vmcnt(7)
    v_mfma_f32_32x32x16_bf16 v[16:31], v[80:83], v[144:147], 0
    v_mfma_f32_32x32x16_bf16 v[32:47], v[80:83], v[148:151], 0
    buffer_load_dwordx4 v[112:115], v8, s[36:39], s66 offen sc1
    buffer_load_dwordx4 v[116:119], v9, s[36:39], s66 offen sc1
    s_add_u32 s66, s66, 8192
    s_add_u32 s67, s67, 1
    s_cmp_eq_u32 s67, 14
    s_cselect_b32 s74, 114688, 0
    s_sub_u32 s66, s66, s74
    v_mfma_f32_32x32x16_bf16 v[48:63], v[84:87], v[144:147], 0
    v_mfma_f32_32x32x16_bf16 v[64:79], v[84:87], v[148:151], 0
    buffer_load_dwordx4 v[120:123], v8, s[36:39], s66 offen sc1
    buffer_load_dwordx4 v[124:127], v9, s[36:39], s66 offen sc1
    s_add_u32 s66, s66, 8192
    s_add_u32 s67, s67, 1
    s_cmp_eq_u32 s67, 14
    s_cselect_b32 s74, 114688, 0
    s_sub_u32 s66, s66, s74
    s_waitcnt vmcnt(9)
    v_mfma_f32_32x32x16_bf16 v[16:31], v[88:91], v[152:155], v[16:31]
    v_mfma_f32_32x32x16_bf16 v[32:47], v[88:91], v[156:159], v[32:47]
    buffer_load_dwordx4 v[128:131], v8, s[36:39], s66 offen sc1
    buffer_load_dwordx4 v[132:135], v9, s[36:39], s66 offen sc1
    s_add_u32 s66, s66, 8192
    s_add_u32 s67, s67, 1
    s_cmp_eq_u32 s67, 14
    s_cselect_b32 s74, 114688, 0
    s_sub_u32 s66, s66, s74
    v_mfma_f32_32x32x16_bf16 v[48:63], v[92:95], v[152:155], v[48:63]
    v_mfma_f32_32x32x16_bf16 v[64:79], v[92:95], v[156:159], v[64:79]
    buffer_load_dwordx4 v[136:139], v8, s[36:39], s66 offen sc1
    buffer_load_dwordx4 v[140:143], v9, s[36:39], s66 offen sc1
    s_add_u32 s66, s66, 8192
    s_add_u32 s67, s67, 1
    s_cmp_eq_u32 s67, 14
    s_cselect_b32 s74, 114688, 0
    s_sub_u32 s66, s66, s74
    s_waitcnt vmcnt(11)
    v_mfma_f32_32x32x16_bf16 v[16:31], v[96:99], v[160:163], v[16:31]
    v_mfma_f32_32x32x16_bf16 v[32:47], v[96:99], v[164:167], v[32:47]
    buffer_load_dwordx4 v[80:83], v8, s[36:39], s66 offen sc1
    buffer_load_dwordx4 v[84:87], v9, s[36:39], s66 offen sc1
    s_add_u32 s66, s66, 8192
    s_add_u32 s67, s67, 1
    s_cmp_eq_u32 s67, 14
    s_cselect_b32 s74, 114688, 0
    s_sub_u32 s66, s66, s74
    v_mfma_f32_32x32x16_bf16 v[48:63], v[100:103], v[160:163], v[48:63]
    v_mfma_f32_32x32x16_bf16 v[64:79], v[100:103], v[164:167], v[64:79]
    buffer_load_dwordx4 v[88:91], v8, s[36:39], s66 offen sc1
    buffer_load_dwordx4 v[92:95], v9, s[36:39], s66 offen sc1
    s_add_u32 s66, s66, 8192
    s_add_u32 s67, s67, 1
    s_cmp_eq_u32 s67, 14
    s_cselect_b32 s74, 114688, 0
    s_sub_u32 s66, s66, s74
    s_waitcnt vmcnt(13)
    v_mfma_f32_32x32x16_bf16 v[16:31], v[104:107], v[168:171], v[16:31]
    s_mov_b32 s44, s30
    s_mov_b32 s45, s31
    s_mov_b32 s46, 1835008
    s_mov_b32 s47, 0x20000
    v_mfma_f32_32x32x16_bf16 v[32:47], v[104:107], v[172:175], v[32:47]
    buffer_load_dwordx4 v[96:99], v8, s[36:39], s66 offen sc1
    buffer_load_dwordx4 v[100:103], v9, s[36:39], s66 offen sc1
    s_add_u32 s66, s66, 8192
    s_add_u32 s67, s67, 1
    s_cmp_eq_u32 s67, 14
    s_cselect_b32 s74, 114688, 0
    s_sub_u32 s66, s66, s74
    v_bfe_u32 v150, v1, 2, 1
    v_lshrrev_b32 v144, 4, v1
    v_lshl_add_u32 v144, v150, 4, v144
    s_lshr_b32 s54, s3, 2
    v_mfma_f32_32x32x16_bf16 v[48:63], v[108:111], v[168:171], v[48:63]
    s_lshl_b32 s54, s54, 5
    s_lshl_b32 s55, s53, 2
    s_add_u32 s54, s54, s55
    v_add_u32 v144, s54, v144
    v_mfma_f32_32x32x16_bf16 v[64:79], v[108:111], v[172:175], v[64:79]
    buffer_load_dwordx4 v[104:107], v8, s[36:39], s66 offen sc1
    buffer_load_dwordx4 v[108:111], v9, s[36:39], s66 offen sc1
    s_add_u32 s66, s66, 8192
    s_add_u32 s67, s67, 1
    s_cmp_eq_u32 s67, 14
    s_cselect_b32 s74, 114688, 0
    s_sub_u32 s66, s66, s74
    v_lshlrev_b32 v144, 8, v144
    v_bfe_u32 v145, v1, 3, 1
    v_lshl_add_u32 v144, v145, 7, v144
    v_and_b32 v145, 3, v1
    s_waitcnt vmcnt(14)
    v_mfma_f32_32x32x16_bf16 v[16:31], v[112:115], v[176:179], v[16:31]
    v_lshl_add_u32 v144, v145, 5, v144
    v_lshl_add_u32 v144, v150, 4, v144
    v_xor_b32 v145, 16, v144
    v_add_u32 v146, 0x10000, v144
    v_mfma_f32_32x32x16_bf16 v[32:47], v[112:115], v[180:183], v[32:47]
    v_add_u32 v147, 0x10000, v145
    v_add_u32 v148, 0x20000, v144
    v_add_u32 v149, 0x20000, v145
    v_mul_f32 v3, v3, v3
    v_mfma_f32_32x32x16_bf16 v[48:63], v[116:119], v[176:179], v[48:63]
    v_lshlrev_b32 v152, 16, v4
    v_and_b32 v153, 0xffff0000, v4
    v_lshlrev_b32 v154, 16, v5
    v_and_b32 v155, 0xffff0000, v5
    v_mfma_f32_32x32x16_bf16 v[64:79], v[116:119], v[180:183], v[64:79]
    buffer_load_dwordx4 v[112:115], v8, s[36:39], s66 offen sc1
    buffer_load_dwordx4 v[116:119], v9, s[36:39], s66 offen sc1
    s_add_u32 s66, s66, 8192
    s_add_u32 s67, s67, 1
    s_cmp_eq_u32 s67, 14
    s_cselect_b32 s74, 114688, 0
    s_sub_u32 s66, s66, s74
    v_lshlrev_b32 v156, 16, v6
    v_and_b32 v157, 0xffff0000, v6
    v_lshlrev_b32 v158, 16, v7
    v_and_b32 v159, 0xffff0000, v7
    s_waitcnt vmcnt(14)
    v_mfma_f32_32x32x16_bf16 v[16:31], v[120:123], v[184:187], v[16:31]
    v_and_b32 v11, 7, v1
    v_lshlrev_b32 v11, 2, v11
    v_add_u32 v11, 46080, v11
    v_and_b32 v15, 4, v1
    v_mfma_f32_32x32x16_bf16 v[32:47], v[120:123], v[188:191], v[32:47]
    v_cmp_eq_u32 vcc, 0, v15
    v_mov_b32 v15, 7
    s_nop 0
    v_cndmask_b32_e64 v15, v15, 21, vcc
    s_lshl_b32 s54, s53, 14
    v_mfma_f32_32x32x16_bf16 v[48:63], v[124:127], v[184:187], v[48:63]
    s_lshr_b32 s55, s53, 1
    s_lshl_b32 s55, s55, 14
    s_add_u32 m0, s54, s55
    v_mfma_f32_32x32x16_bf16 v[64:79], v[124:127], v[188:191], v[64:79]
    buffer_load_dwordx4 v[120:123], v8, s[36:39], s66 offen sc1
    buffer_load_dwordx4 v[124:127], v9, s[36:39], s66 offen sc1
    s_waitcnt vmcnt(14)
    v_mfma_f32_32x32x16_bf16 v[16:31], v[128:131], v[192:195], v[16:31]
    v_mfma_f32_32x32x16_bf16 v[32:47], v[128:131], v[196:199], v[32:47]
    v_mfma_f32_32x32x16_bf16 v[48:63], v[132:135], v[192:195], v[48:63]
    v_mfma_f32_32x32x16_bf16 v[64:79], v[132:135], v[196:199], v[64:79]
    s_waitcnt vmcnt(12)
    v_mfma_f32_32x32x16_bf16 v[16:31], v[136:139], v[200:203], v[16:31]
    v_mfma_f32_32x32x16_bf16 v[32:47], v[136:139], v[204:207], v[32:47]
    v_mfma_f32_32x32x16_bf16 v[48:63], v[140:143], v[200:203], v[48:63]
    v_mfma_f32_32x32x16_bf16 v[64:79], v[140:143], v[204:207], v[64:79]
    s_waitcnt vmcnt(10)
    v_mfma_f32_32x32x16_bf16 v[16:31], v[80:83], v[208:211], v[16:31]
    v_mfma_f32_32x32x16_bf16 v[32:47], v[80:83], v[212:215], v[32:47]
    v_mfma_f32_32x32x16_bf16 v[48:63], v[84:87], v[208:211], v[48:63]
    v_mfma_f32_32x32x16_bf16 v[64:79], v[84:87], v[212:215], v[64:79]
    s_waitcnt vmcnt(8)
    v_mfma_f32_32x32x16_bf16 v[16:31], v[88:91], v[216:219], v[16:31]
    v_mfma_f32_32x32x16_bf16 v[32:47], v[88:91], v[220:223], v[32:47]
    v_mfma_f32_32x32x16_bf16 v[48:63], v[92:95], v[216:219], v[48:63]
    v_mfma_f32_32x32x16_bf16 v[64:79], v[92:95], v[220:223], v[64:79]
    s_waitcnt vmcnt(6)
    v_mfma_f32_32x32x16_bf16 v[16:31], v[96:99], v[224:227], v[16:31]
    v_mfma_f32_32x32x16_bf16 v[32:47], v[96:99], v[228:231], v[32:47]
    v_mfma_f32_32x32x16_bf16 v[48:63], v[100:103], v[224:227], v[48:63]
    v_mfma_f32_32x32x16_bf16 v[64:79], v[100:103], v[228:231], v[64:79]
    s_waitcnt vmcnt(4)
    v_mfma_f32_32x32x16_bf16 v[16:31], v[104:107], v[232:235], v[16:31]
    v_mfma_f32_32x32x16_bf16 v[32:47], v[104:107], v[236:239], v[32:47]
    v_mfma_f32_32x32x16_bf16 v[48:63], v[108:111], v[232:235], v[48:63]
    v_mfma_f32_32x32x16_bf16 v[64:79], v[108:111], v[236:239], v[64:79]
    s_waitcnt vmcnt(2)
    v_mfma_f32_32x32x16_bf16 v[16:31], v[112:115], v[240:243], v[16:31]
    v_mfma_f32_32x32x16_bf16 v[32:47], v[112:115], v[244:247], v[32:47]
    v_mfma_f32_32x32x16_bf16 v[48:63], v[116:119], v[240:243], v[48:63]
    v_mfma_f32_32x32x16_bf16 v[64:79], v[116:119], v[244:247], v[64:79]
    ds_read_b32 v13, v11
    s_waitcnt vmcnt(0)
    v_mfma_f32_32x32x16_bf16 v[16:31], v[120:123], v[248:251], v[16:31]
    v_mfma_f32_32x32x16_bf16 v[32:47], v[120:123], v[252:255], v[32:47]
    v_mfma_f32_32x32x16_bf16 v[48:63], v[124:127], v[248:251], v[48:63]
    v_mfma_f32_32x32x16_bf16 v[64:79], v[124:127], v[252:255], v[64:79]
    s_waitcnt lgkmcnt(0)
    v_cmp_gt_u32 vcc, v15, v13
    s_cbranch_vccnz L_spin_31
L_sdone_32:
    s_nop 5
    ds_write_addtid_b32 v16 offset:0
    ds_write_addtid_b32 v17 offset:256
    ds_write_addtid_b32 v18 offset:512
    ds_write_addtid_b32 v19 offset:768
    ds_write_addtid_b32 v20 offset:1024
    ds_write_addtid_b32 v21 offset:1280
    ds_write_addtid_b32 v22 offset:1536
    ds_write_addtid_b32 v23 offset:1792
    ds_write_addtid_b32 v24 offset:2048
    ds_write_addtid_b32 v25 offset:2304
    ds_write_addtid_b32 v26 offset:2560
    ds_write_addtid_b32 v27 offset:2816
    ds_write_addtid_b32 v28 offset:3072
    ds_write_addtid_b32 v29 offset:3328
    ds_write_addtid_b32 v30 offset:3584
    ds_write_addtid_b32 v31 offset:3840
    ds_write_addtid_b32 v32 offset:4096
    ds_write_addtid_b32 v33 offset:4352
    ds_write_addtid_b32 v34 offset:4608
    ds_write_addtid_b32 v35 offset:4864
    ds_write_addtid_b32 v36 offset:5120
    ds_write_addtid_b32 v37 offset:5376
    ds_write_addtid_b32 v38 offset:5632
    ds_write_addtid_b32 v39 offset:5888
    ds_write_addtid_b32 v40 offset:6144
    ds_write_addtid_b32 v41 offset:6400
    ds_write_addtid_b32 v42 offset:6656
    ds_write_addtid_b32 v43 offset:6912
    ds_write_addtid_b32 v44 offset:7168
    ds_write_addtid_b32 v45 offset:7424
    ds_write_addtid_b32 v46 offset:7680
    ds_write_addtid_b32 v47 offset:7936
    ds_write_addtid_b32 v48 offset:8192
    ds_write_addtid_b32 v49 offset:8448
    ds_write_addtid_b32 v50 offset:8704
    ds_write_addtid_b32 v51 offset:8960
    ds_write_addtid_b32 v52 offset:9216
    ds_write_addtid_b32 v53 offset:9472
    ds_write_addtid_b32 v54 offset:9728
    ds_write_addtid_b32 v55 offset:9984
    ds_write_addtid_b32 v56 offset:10240
    ds_write_addtid_b32 v57 offset:10496
    ds_write_addtid_b32 v58 offset:10752
    ds_write_addtid_b32 v59 offset:11008
    ds_write_addtid_b32 v60 offset:11264
    ds_write_addtid_b32 v61 offset:11520
    ds_write_addtid_b32 v62 offset:11776
    ds_write_addtid_b32 v63 offset:12032
    ds_write_addtid_b32 v64 offset:12288
    ds_write_addtid_b32 v65 offset:12544
    ds_write_addtid_b32 v66 offset:12800
    ds_write_addtid_b32 v67 offset:13056
    ds_write_addtid_b32 v68 offset:13312
    ds_write_addtid_b32 v69 offset:13568
    ds_write_addtid_b32 v70 offset:13824
    ds_write_addtid_b32 v71 offset:14080
    ds_write_addtid_b32 v72 offset:14336
    ds_write_addtid_b32 v73 offset:14592
    ds_write_addtid_b32 v74 offset:14848
    ds_write_addtid_b32 v75 offset:15104
    ds_write_addtid_b32 v76 offset:15360
    ds_write_addtid_b32 v77 offset:15616
    ds_write_addtid_b32 v78 offset:15872
    ds_write_addtid_b32 v79 offset:16128
L_fin:
    v_cmp_eq_u32 vcc, 1, v150
    s_waitcnt lgkmcnt(0)
    s_barrier
    ds_read_b128 v[80:83], v148 offset:16384
    ds_read_b128 v[84:87], v149 offset:16384
    ds_read_b128 v[16:19], v146 offset:16384
    ds_read_b128 v[20:23], v147 offset:16384
    ds_read_b128 v[24:27], v146 offset:32768
    ds_read_b128 v[28:31], v147 offset:32768
    ds_read_b128 v[32:35], v146 offset:49152
    ds_read_b128 v[36:39], v147 offset:49152
    ds_read_b128 v[40:43], v148 offset:0
    ds_read_b128 v[44:47], v149 offset:0
    ds_read_b128 v[48:51], v144 offset:0
    ds_read_b128 v[52:55], v145 offset:0
    ds_read_b128 v[56:59], v144 offset:16384
    ds_read_b128 v[60:63], v145 offset:16384
    ds_read_b128 v[64:67], v144 offset:49152
    ds_read_b128 v[68:71], v145 offset:49152
    ds_read_b128 v[72:75], v146 offset:0
    ds_read_b128 v[76:79], v147 offset:0
    s_waitcnt lgkmcnt(12)
    v_add_f32 v16, v16, v24
    v_add_f32 v17, v17, v25
    v_add_f32 v18, v18, v26
    v_add_f32 v19, v19, v27
    v_add_f32 v20, v20, v28
    v_add_f32 v21, v21, v29
    v_add_f32 v22, v22, v30
    v_add_f32 v23, v23, v31
    s_waitcnt lgkmcnt(10)
    v_add_f32 v16, v16, v32
    v_add_f32 v17, v17, v33
    v_add_f32 v18, v18, v34
    v_add_f32 v19, v19, v35
    v_add_f32 v20, v20, v36
    v_add_f32 v21, v21, v37
    v_add_f32 v22, v22, v38
    v_add_f32 v23, v23, v39
    s_waitcnt lgkmcnt(8)
    v_add_f32 v16, v16, v40
    v_add_f32 v17, v17, v41
    v_add_f32 v18, v18, v42
    v_add_f32 v19, v19, v43
    v_add_f32 v20, v20, v44
    v_add_f32 v21, v21, v45
    v_add_f32 v22, v22, v46
    v_add_f32 v23, v23, v47
    s_waitcnt lgkmcnt(6)
    v_add_f32 v16, v16, v48
    v_add_f32 v17, v17, v49
    v_add_f32 v18, v18, v50
    v_add_f32 v19, v19, v51
    v_add_f32 v20, v20, v52
    v_add_f32 v21, v21, v53
    v_add_f32 v22, v22, v54
    v_add_f32 v23, v23, v55
    s_waitcnt lgkmcnt(4)
    v_add_f32 v16, v16, v56
    v_add_f32 v17, v17, v57
    v_add_f32 v18, v18, v58
    v_add_f32 v19, v19, v59
    v_add_f32 v20, v20, v60
    v_add_f32 v21, v21, v61
    v_add_f32 v22, v22, v62
    v_add_f32 v23, v23, v63
    s_waitcnt lgkmcnt(2)
    v_add_f32 v16, v16, v64
    v_add_f32 v17, v17, v65
    v_add_f32 v18, v18, v66
    v_add_f32 v19, v19, v67
    v_add_f32 v20, v20, v68
    v_add_f32 v21, v21, v69
    v_add_f32 v22, v22, v70
    v_add_f32 v23, v23, v71
    s_waitcnt lgkmcnt(0)
    v_add_f32 v16, v16, v72
    v_add_f32 v17, v17, v73
    v_add_f32 v18, v18, v74
    v_add_f32 v19, v19, v75
    v_add_f32 v20, v20, v76
    v_add_f32 v21, v21, v77
    v_add_f32 v22, v22, v78
    v_add_f32 v23, v23, v79
    v_fmac_f32 v80, v3, v16
    v_fmac_f32 v81, v3, v17
    v_fmac_f32 v82, v3, v18
    v_fmac_f32 v83, v3, v19
    v_fmac_f32 v84, v3, v20
    v_fmac_f32 v85, v3, v21
    v_fmac_f32 v86, v3, v22
    v_fmac_f32 v87, v3, v23
    v_cndmask_b32 v16, v80, v84, vcc
    v_cndmask_b32 v20, v84, v80, vcc
    v_cndmask_b32 v17, v81, v85, vcc
    v_cndmask_b32 v21, v85, v81, vcc
    v_cndmask_b32 v18, v82, v86, vcc
    v_cndmask_b32 v22, v86, v82, vcc
    v_cndmask_b32 v19, v83, v87, vcc
    v_cndmask_b32 v23, v87, v83, vcc
    v_add_f32 v16, v16, v152
    v_add_f32 v17, v17, v153
    v_add_f32 v18, v18, v154
    v_add_f32 v19, v19, v155
    v_add_f32 v20, v20, v156
    v_add_f32 v21, v21, v157
    v_add_f32 v22, v22, v158
    v_add_f32 v23, v23, v159
    v_cvt_pk_bf16_f32 v16, v16, v17
    v_cvt_pk_bf16_f32 v17, v18, v19
    v_cvt_pk_bf16_f32 v18, v20, v21
    v_cvt_pk_bf16_f32 v19, v22, v23
    buffer_store_dwordx4 v[16:19], v2, s[44:47], s70 offen sc1
    s_endpgm
L_aux:
    s_sub_u32 s65, s65, 28
    s_and_b32 s54, s64, 3
    s_lshr_b32 s55, s64, 2
    s_lshl_b32 s66, s54, 3
    s_lshl_b32 s56, s55, 2
    s_add_u32 s66, s66, s56
    s_add_u32 s66, s66, s65
    s_lshl_b32 s67, s54, 2
    s_add_u32 s67, s67, s65
    s_min_u32 s56, s67, 13
    s_and_b32 s68, s56, 1
    s_lshr_b32 s56, s56, 1
    s_mul_i32 s60, s55, 7
    s_add_u32 s60, s60, s56
    v_lshrrev_b32 v2, 3, v1
    v_and_b32 v3, 7, v1
    v_mul_u32_u24 v4, 896, v2
    v_lshl_add_u32 v4, v3, 4, v4
    v_mul_u32_u24 v5, 3584, v2
    v_lshl_add_u32 v5, v3, 4, v5
    s_lshl_b32 s54, s66, 3
    s_add_u32 s54, s54, s3
    s_mul_i32 s54, s54, 7168
    s_mul_i32 s55, s3, 200704
    s_lshl_b32 s56, s60, 8
    s_add_u32 s55, s55, s56
    s_lshl_b32 s56, s68, 7
    s_add_u32 s63, s55, s56
    s_mov_b32 s69, 0x3f803f80
    s_mov_b32 s70, 0x00003f80
    s_mov_b32 s71, 0x3f800000
    s_waitcnt lgkmcnt(0)
    s_mov_b32 s36, s34
    s_mov_b32 s37, s35
    s_mov_b32 s38, 16777216
    s_mov_b32 s39, 0x20000
    s_mov_b32 s40, s4
    s_mov_b32 s41, s5
    s_mov_b32 s42, 1835008
    s_mov_b32 s43, 0x20000
    s_mov_b32 s44, s24
    s_mov_b32 s45, s25
    s_mov_b32 s46, 1605632
    s_mov_b32 s47, 0x20000
    s_mov_b32 s48, s26
    s_mov_b32 s49, s27
    s_mov_b32 s50, 1605632
    s_mov_b32 s51, 0x20000
    buffer_load_dwordx4 v[16:19], v4, s[40:43], s54 offen offset:0
    buffer_load_dwordx4 v[20:23], v4, s[40:43], s54 offen offset:128
    buffer_load_dwordx4 v[24:27], v4, s[40:43], s54 offen offset:256
    buffer_load_dwordx4 v[28:31], v4, s[40:43], s54 offen offset:384
    buffer_load_dwordx4 v[32:35], v4, s[40:43], s54 offen offset:512
    buffer_load_dwordx4 v[36:39], v4, s[40:43], s54 offen offset:640
    buffer_load_dwordx4 v[40:43], v4, s[40:43], s54 offen offset:768
    v_mov_b32 v44, 0
    v_mov_b32 v45, 0
    v_mov_b32 v46, 0
    v_mov_b32 v47, 0
    s_cmp_lg_u32 s2, 224
    s_cbranch_scc1 L_nonn_33
    s_cmp_lg_u32 s3, 0
    s_cbranch_scc1 L_nonn_33
    s_load_dword s52, s[34:35], 0 glc
    s_waitcnt lgkmcnt(0)
    s_add_u32 s52, s52, 1
    s_max_u32 s52, s52, 1
    s_atomic_swap s52, s[32:33], 0
    s_atomic_swap s52, s[34:35], 0
    s_waitcnt lgkmcnt(0)
L_nonn_33:
    s_waitcnt vmcnt(6)
    v_dot2c_f32_bf16 v44, s69, v16
    v_dot2c_f32_bf16 v45, s69, v17
    v_dot2c_f32_bf16 v46, s69, v18
    v_dot2c_f32_bf16 v47, s69, v19
    s_waitcnt vmcnt(5)
    v_dot2c_f32_bf16 v44, s69, v20
    v_dot2c_f32_bf16 v45, s69, v21
    v_dot2c_f32_bf16 v46, s69, v22
    v_dot2c_f32_bf16 v47, s69, v23
    s_waitcnt vmcnt(4)
    v_dot2c_f32_bf16 v44, s69, v24
    v_dot2c_f32_bf16 v45, s69, v25
    v_dot2c_f32_bf16 v46, s69, v26
    v_dot2c_f32_bf16 v47, s69, v27
    s_waitcnt vmcnt(3)
    v_dot2c_f32_bf16 v44, s69, v28
    v_dot2c_f32_bf16 v45, s69, v29
    v_dot2c_f32_bf16 v46, s69, v30
    v_dot2c_f32_bf16 v47, s69, v31
    s_waitcnt vmcnt(2)
    v_dot2c_f32_bf16 v44, s69, v32
    v_dot2c_f32_bf16 v45, s69, v33
    v_dot2c_f32_bf16 v46, s69, v34
    v_dot2c_f32_bf16 v47, s69, v35
    s_waitcnt vmcnt(1)
    v_dot2c_f32_bf16 v44, s69, v36
    v_dot2c_f32_bf16 v45, s69, v37
    v_dot2c_f32_bf16 v46, s69, v38
    v_dot2c_f32_bf16 v47, s69, v39
    s_waitcnt vmcnt(0)
    v_dot2c_f32_bf16 v44, s69, v40
    v_dot2c_f32_bf16 v45, s69, v41
    v_dot2c_f32_bf16 v46, s69, v42
    v_dot2c_f32_bf16 v47, s69, v43
    s_nop 0
    v_add_f32 v44, v44, v45
    s_nop 0
    v_add_f32 v46, v46, v47
    v_add_f32 v44, v44, v46
    s_nop 1
    v_add_f32_dpp v45, v44, v44 quad_perm:[1,0,3,2] row_mask:0xf bank_mask:0xf bound_ctrl:1
    s_nop 1
    v_add_f32_dpp v44, v45, v45 quad_perm:[2,3,0,1] row_mask:0xf bank_mask:0xf bound_ctrl:1
    s_nop 1
    v_add_f32_dpp v45, v44, v44 row_half_mirror row_mask:0xf bank_mask:0xf bound_ctrl:1
    v_mul_f32 v44, 0x3b124925, v45
    v_cvt_pk_bf16_f32 v48, v44, v44
    v_lshlrev_b32 v48, 16, v48
    v_sub_f32 v49, 0, v48
    v_sub_f32 v50, v44, v48
    v_dot2_f32_bf16 v120, v16, s70, v49
    v_dot2_f32_bf16 v121, v16, s71, v49
    v_dot2_f32_bf16 v122, v17, s70, v49
    v_dot2_f32_bf16 v123, v17, s71, v49
    v_dot2_f32_bf16 v124, v18, s70, v49
    v_dot2_f32_bf16 v125, v18, s71, v49
    v_dot2_f32_bf16 v126, v19, s70, v49
    v_dot2_f32_bf16 v127, v19, s71, v49
    v_dot2_f32_bf16 v128, v20, s70, v49
    v_dot2_f32_bf16 v129, v20, s71, v49
    v_dot2_f32_bf16 v130, v21, s70, v49
    v_dot2_f32_bf16 v131, v21, s71, v49
    v_dot2_f32_bf16 v132, v22, s70, v49
    v_dot2_f32_bf16 v133, v22, s71, v49
    v_dot2_f32_bf16 v134, v23, s70, v49
    v_dot2_f32_bf16 v135, v23, s71, v49
    v_dot2_f32_bf16 v136, v24, s70, v49
    v_dot2_f32_bf16 v137, v24, s71, v49
    v_dot2_f32_bf16 v138, v25, s70, v49
    v_dot2_f32_bf16 v139, v25, s71, v49
    v_dot2_f32_bf16 v140, v26, s70, v49
    v_dot2_f32_bf16 v141, v26, s71, v49
    v_dot2_f32_bf16 v142, v27, s70, v49
    v_dot2_f32_bf16 v143, v27, s71, v49
    v_dot2_f32_bf16 v144, v28, s70, v49
    v_dot2_f32_bf16 v145, v28, s71, v49
    v_dot2_f32_bf16 v146, v29, s70, v49
    v_dot2_f32_bf16 v147, v29, s71, v49
    v_dot2_f32_bf16 v148, v30, s70, v49
    v_dot2_f32_bf16 v149, v30, s71, v49
    v_dot2_f32_bf16 v150, v31, s70, v49
    v_dot2_f32_bf16 v151, v31, s71, v49
    v_dot2_f32_bf16 v152, v32, s70, v49
    v_dot2_f32_bf16 v153, v32, s71, v49
    v_dot2_f32_bf16 v154, v33, s70, v49
    v_dot2_f32_bf16 v155, v33, s71, v49
    v_dot2_f32_bf16 v156, v34, s70, v49
    v_dot2_f32_bf16 v157, v34, s71, v49
    v_dot2_f32_bf16 v158, v35, s70, v49
    v_dot2_f32_bf16 v159, v35, s71, v49
    v_dot2_f32_bf16 v160, v36, s70, v49
    v_dot2_f32_bf16 v161, v36, s71, v49
    v_dot2_f32_bf16 v162, v37, s70, v49
    v_dot2_f32_bf16 v163, v37, s71, v49
    v_dot2_f32_bf16 v164, v38, s70, v49
    v_dot2_f32_bf16 v165, v38, s71, v49
    v_dot2_f32_bf16 v166, v39, s70, v49
    v_dot2_f32_bf16 v167, v39, s71, v49
    v_dot2_f32_bf16 v168, v40, s70, v49
    v_dot2_f32_bf16 v169, v40, s71, v49
    v_dot2_f32_bf16 v170, v41, s70, v49
    v_dot2_f32_bf16 v171, v41, s71, v49
    v_dot2_f32_bf16 v172, v42, s70, v49
    v_dot2_f32_bf16 v173, v42, s71, v49
    v_dot2_f32_bf16 v174, v43, s70, v49
    v_dot2_f32_bf16 v175, v43, s71, v49
    v_pk_mul_f32 v[44:45], v[120:121], v[120:121]
    v_pk_mul_f32 v[46:47], v[122:123], v[122:123]
    v_pk_fma_f32 v[44:45], v[124:125], v[124:125], v[44:45]
    v_pk_fma_f32 v[46:47], v[126:127], v[126:127], v[46:47]
    v_pk_fma_f32 v[44:45], v[128:129], v[128:129], v[44:45]
    v_pk_fma_f32 v[46:47], v[130:131], v[130:131], v[46:47]
    v_pk_fma_f32 v[44:45], v[132:133], v[132:133], v[44:45]
    v_pk_fma_f32 v[46:47], v[134:135], v[134:135], v[46:47]
    v_pk_fma_f32 v[44:45], v[136:137], v[136:137], v[44:45]
    v_pk_fma_f32 v[46:47], v[138:139], v[138:139], v[46:47]
    v_pk_fma_f32 v[44:45], v[140:141], v[140:141], v[44:45]
    v_pk_fma_f32 v[46:47], v[142:143], v[142:143], v[46:47]
    v_pk_fma_f32 v[44:45], v[144:145], v[144:145], v[44:45]
    v_pk_fma_f32 v[46:47], v[146:147], v[146:147], v[46:47]
    v_pk_fma_f32 v[44:45], v[148:149], v[148:149], v[44:45]
    v_pk_fma_f32 v[46:47], v[150:151], v[150:151], v[46:47]
    v_pk_fma_f32 v[44:45], v[152:153], v[152:153], v[44:45]
    v_pk_fma_f32 v[46:47], v[154:155], v[154:155], v[46:47]
    v_pk_fma_f32 v[44:45], v[156:157], v[156:157], v[44:45]
    v_pk_fma_f32 v[46:47], v[158:159], v[158:159], v[46:47]
    v_pk_fma_f32 v[44:45], v[160:161], v[160:161], v[44:45]
    v_pk_fma_f32 v[46:47], v[162:163], v[162:163], v[46:47]
    v_pk_fma_f32 v[44:45], v[164:165], v[164:165], v[44:45]
    v_pk_fma_f32 v[46:47], v[166:167], v[166:167], v[46:47]
    v_pk_fma_f32 v[44:45], v[168:169], v[168:169], v[44:45]
    v_pk_fma_f32 v[46:47], v[170:171], v[170:171], v[46:47]
    v_pk_fma_f32 v[44:45], v[172:173], v[172:173], v[44:45]
    v_pk_fma_f32 v[46:47], v[174:175], v[174:175], v[46:47]
    v_add_f32 v44, v44, v45
    v_add_f32 v46, v46, v47
    v_add_f32 v44, v44, v46
    s_nop 1
    v_add_f32_dpp v45, v44, v44 quad_perm:[1,0,3,2] row_mask:0xf bank_mask:0xf bound_ctrl:1
    s_nop 1
    v_add_f32_dpp v44, v45, v45 quad_perm:[2,3,0,1] row_mask:0xf bank_mask:0xf bound_ctrl:1
    s_nop 1
    v_add_f32_dpp v45, v44, v44 row_half_mirror row_mask:0xf bank_mask:0xf bound_ctrl:1
    v_mul_f32 v44, 0x3b124925, v45
    v_fma_f32 v44, -v50, v50, v44
    v_max_f32 v44, 0, v44
    v_cvt_pk_bf16_f32 v44, v44, v44
    v_lshlrev_b32 v44, 16, v44
    v_add_f32 v44, 0x3727c5ac, v44
    v_cvt_pk_bf16_f32 v44, v44, v44
    v_lshlrev_b32 v44, 16, v44
    v_sqrt_f32 v44, v44
    s_nop 0
    v_cvt_pk_bf16_f32 v44, v44, v44
    v_lshlrev_b32 v44, 16, v44
    v_rcp_f32 v49, v44
    s_lshl_b32 s54, s66, 3
    s_add_u32 s54, s54, s3
    s_lshl_b32 s54, s54, 6
    s_add_u32 s54, s54, 32768
    v_lshlrev_b32 v6, 3, v2
    s_mov_b32 exec_lo, 0x01010101
    s_mov_b32 exec_hi, 0x01010101
    buffer_store_dwordx2 v[48:49], v6, s[36:39], s54 offen sc1
    s_mov_b64 exec, -1
    v_pk_mul_f32 v[120:121], v[120:121], v[48:49] op_sel:[0,1] op_sel_hi:[1,1]
    v_pk_mul_f32 v[122:123], v[122:123], v[48:49] op_sel:[0,1] op_sel_hi:[1,1]
    v_pk_mul_f32 v[124:125], v[124:125], v[48:49] op_sel:[0,1] op_sel_hi:[1,1]
    v_pk_mul_f32 v[126:127], v[126:127], v[48:49] op_sel:[0,1] op_sel_hi:[1,1]
    v_pk_mul_f32 v[128:129], v[128:129], v[48:49] op_sel:[0,1] op_sel_hi:[1,1]
    v_pk_mul_f32 v[130:131], v[130:131], v[48:49] op_sel:[0,1] op_sel_hi:[1,1]
    v_pk_mul_f32 v[132:133], v[132:133], v[48:49] op_sel:[0,1] op_sel_hi:[1,1]
    v_pk_mul_f32 v[134:135], v[134:135], v[48:49] op_sel:[0,1] op_sel_hi:[1,1]
    v_pk_mul_f32 v[136:137], v[136:137], v[48:49] op_sel:[0,1] op_sel_hi:[1,1]
    v_pk_mul_f32 v[138:139], v[138:139], v[48:49] op_sel:[0,1] op_sel_hi:[1,1]
    v_pk_mul_f32 v[140:141], v[140:141], v[48:49] op_sel:[0,1] op_sel_hi:[1,1]
    v_pk_mul_f32 v[142:143], v[142:143], v[48:49] op_sel:[0,1] op_sel_hi:[1,1]
    v_pk_mul_f32 v[144:145], v[144:145], v[48:49] op_sel:[0,1] op_sel_hi:[1,1]
    v_pk_mul_f32 v[146:147], v[146:147], v[48:49] op_sel:[0,1] op_sel_hi:[1,1]
    v_pk_mul_f32 v[148:149], v[148:149], v[48:49] op_sel:[0,1] op_sel_hi:[1,1]
    v_pk_mul_f32 v[150:151], v[150:151], v[48:49] op_sel:[0,1] op_sel_hi:[1,1]
    v_pk_mul_f32 v[152:153], v[152:153], v[48:49] op_sel:[0,1] op_sel_hi:[1,1]
    v_pk_mul_f32 v[154:155], v[154:155], v[48:49] op_sel:[0,1] op_sel_hi:[1,1]
    v_pk_mul_f32 v[156:157], v[156:157], v[48:49] op_sel:[0,1] op_sel_hi:[1,1]
    v_pk_mul_f32 v[158:159], v[158:159], v[48:49] op_sel:[0,1] op_sel_hi:[1,1]
    v_pk_mul_f32 v[160:161], v[160:161], v[48:49] op_sel:[0,1] op_sel_hi:[1,1]
    v_pk_mul_f32 v[162:163], v[162:163], v[48:49] op_sel:[0,1] op_sel_hi:[1,1]
    v_pk_mul_f32 v[164:165], v[164:165], v[48:49] op_sel:[0,1] op_sel_hi:[1,1]
    v_pk_mul_f32 v[166:167], v[166:167], v[48:49] op_sel:[0,1] op_sel_hi:[1,1]
    v_pk_mul_f32 v[168:169], v[168:169], v[48:49] op_sel:[0,1] op_sel_hi:[1,1]
    v_pk_mul_f32 v[170:171], v[170:171], v[48:49] op_sel:[0,1] op_sel_hi:[1,1]
    v_pk_mul_f32 v[172:173], v[172:173], v[48:49] op_sel:[0,1] op_sel_hi:[1,1]
    v_pk_mul_f32 v[174:175], v[174:175], v[48:49] op_sel:[0,1] op_sel_hi:[1,1]
    v_cvt_pk_bf16_f32 v16, v120, v121
    v_cvt_pk_bf16_f32 v17, v122, v123
    v_cvt_pk_bf16_f32 v18, v124, v125
    v_cvt_pk_bf16_f32 v19, v126, v127
    v_cvt_pk_bf16_f32 v20, v128, v129
    v_cvt_pk_bf16_f32 v21, v130, v131
    v_cvt_pk_bf16_f32 v22, v132, v133
    v_cvt_pk_bf16_f32 v23, v134, v135
    v_cvt_pk_bf16_f32 v24, v136, v137
    v_cvt_pk_bf16_f32 v25, v138, v139
    v_cvt_pk_bf16_f32 v26, v140, v141
    v_cvt_pk_bf16_f32 v27, v142, v143
    v_cvt_pk_bf16_f32 v28, v144, v145
    v_cvt_pk_bf16_f32 v29, v146, v147
    v_cvt_pk_bf16_f32 v30, v148, v149
    v_cvt_pk_bf16_f32 v31, v150, v151
    v_cvt_pk_bf16_f32 v32, v152, v153
    v_cvt_pk_bf16_f32 v33, v154, v155
    v_cvt_pk_bf16_f32 v34, v156, v157
    v_cvt_pk_bf16_f32 v35, v158, v159
    v_cvt_pk_bf16_f32 v36, v160, v161
    v_cvt_pk_bf16_f32 v37, v162, v163
    v_cvt_pk_bf16_f32 v38, v164, v165
    v_cvt_pk_bf16_f32 v39, v166, v167
    v_cvt_pk_bf16_f32 v40, v168, v169
    v_cvt_pk_bf16_f32 v41, v170, v171
    v_cvt_pk_bf16_f32 v42, v172, v173
    v_cvt_pk_bf16_f32 v43, v174, v175
    s_mul_i32 s54, s3, 7296
    s_add_u32 s54, s54, 0
    v_mul_u32_u24 v6, 912, v2
    v_lshl_add_u32 v6, v3, 4, v6
    v_add_u32 v6, s54, v6
    ds_write_b128 v6, v[16:19] offset:0
    ds_write_b128 v6, v[20:23] offset:128
    ds_write_b128 v6, v[24:27] offset:256
    ds_write_b128 v6, v[28:31] offset:384
    ds_write_b128 v6, v[32:35] offset:512
    ds_write_b128 v6, v[36:39] offset:640
    ds_write_b128 v6, v[40:43] offset:768
    v_lshrrev_b32 v7, 4, v1
    v_bfe_u32 v8, v1, 2, 2
    v_lshl_add_u32 v8, v7, 3, v8
    v_mul_u32_u24 v8, 912, v8
    v_and_b32 v9, 3, v1
    v_lshl_add_u32 v8, v9, 3, v8
    s_lshl_b32 s54, s3, 5
    s_add_u32 s54, s54, 0
    v_add_u32 v8, s54, v8
    v_and_b32 v9, 15, v1
    v_mul_u32_u24 v9, 144, v9
    v_lshl_add_u32 v9, v7, 4, v9
    s_mul_i32 s54, s3, 9216
    s_add_u32 s54, s54, 58368
    v_add_u32 v9, s54, v9
    v_mul_u32_u24 v11, 144, v2
    v_lshl_add_u32 v11, v3, 4, v11
    v_add_u32 v11, s54, v11
    v_lshlrev_b32 v13, 12, v2
    v_lshl_add_u32 v13, v3, 4, v13
    s_lshl_b32 s54, s3, 16
    s_lshl_b32 s55, s66, 7
    s_add_u32 s54, s54, s55
    s_add_u32 s54, s54, 1048576
    s_cmp_ge_u32 s3, 4
    s_cselect_b32 s56, 16777216, 0
    s_waitcnt lgkmcnt(0)
    s_barrier
    ds_read_b64_tr_b16 v[16:17], v8 offset:0
    ds_read_b64_tr_b16 v[18:19], v8 offset:3648
    ds_read_b64_tr_b16 v[20:21], v8 offset:29184
    ds_read_b64_tr_b16 v[22:23], v8 offset:32832
    ds_read_b64_tr_b16 v[24:25], v8 offset:256
    ds_read_b64_tr_b16 v[26:27], v8 offset:3904
    ds_read_b64_tr_b16 v[28:29], v8 offset:29440
    ds_read_b64_tr_b16 v[30:31], v8 offset:33088
    ds_read_b64_tr_b16 v[32:33], v8 offset:512
    ds_read_b64_tr_b16 v[34:35], v8 offset:4160
    ds_read_b64_tr_b16 v[36:37], v8 offset:29696
    ds_read_b64_tr_b16 v[38:39], v8 offset:33344
    ds_read_b64_tr_b16 v[40:41], v8 offset:768
    ds_read_b64_tr_b16 v[42:43], v8 offset:4416
    ds_read_b64_tr_b16 v[44:45], v8 offset:29952
    ds_read_b64_tr_b16 v[46:47], v8 offset:33600
    s_waitcnt lgkmcnt(14)
    ds_write_b128 v9, v[16:19] offset:0
    s_waitcnt lgkmcnt(13)
    ds_write_b128 v9, v[20:23] offset:64
    s_waitcnt lgkmcnt(12)
    ds_write_b128 v9, v[24:27] offset:2304
    s_waitcnt lgkmcnt(11)
    ds_write_b128 v9, v[28:31] offset:2368
    s_waitcnt lgkmcnt(10)
    ds_write_b128 v9, v[32:35] offset:4608
    s_waitcnt lgkmcnt(9)
    ds_write_b128 v9, v[36:39] offset:4672
    s_waitcnt lgkmcnt(8)
    ds_write_b128 v9, v[40:43] offset:6912
    s_waitcnt lgkmcnt(7)
    ds_write_b128 v9, v[44:47] offset:6976
    ds_read_b128 v[120:123], v11 offset:0
    ds_read_b128 v[124:127], v11 offset:1152
    ds_read_b128 v[128:131], v11 offset:2304
    ds_read_b128 v[132:135], v11 offset:3456
    ds_read_b128 v[136:139], v11 offset:4608
    ds_read_b128 v[140:143], v11 offset:5760
    ds_read_b128 v[144:147], v11 offset:6912
    ds_read_b128 v[148:151], v11 offset:8064
    s_waitcnt lgkmcnt(7)
    buffer_store_dwordx4 v[120:123], v13, s[36:39], s54 offen sc1
    s_add_u32 s54, s54, 32768
    s_waitcnt lgkmcnt(6)
    buffer_store_dwordx4 v[124:127], v13, s[36:39], s54 offen sc1
    s_add_u32 s54, s54, 491520
    s_waitcnt lgkmcnt(5)
    buffer_store_dwordx4 v[128:131], v13, s[36:39], s54 offen sc1
    s_add_u32 s54, s54, 32768
    s_waitcnt lgkmcnt(4)
    buffer_store_dwordx4 v[132:135], v13, s[36:39], s54 offen sc1
    s_add_u32 s54, s54, 491520
    s_waitcnt lgkmcnt(3)
    buffer_store_dwordx4 v[136:139], v13, s[36:39], s54 offen sc1
    s_add_u32 s54, s54, 32768
    s_waitcnt lgkmcnt(2)
    buffer_store_dwordx4 v[140:143], v13, s[36:39], s54 offen sc1
    s_add_u32 s54, s54, 491520
    s_add_u32 s54, s54, s56
    s_waitcnt lgkmcnt(1)
    buffer_store_dwordx4 v[144:147], v13, s[36:39], s54 offen sc1
    s_add_u32 s54, s54, 32768
    s_waitcnt lgkmcnt(0)
    buffer_store_dwordx4 v[148:151], v13, s[36:39], s54 offen sc1
    s_add_u32 s54, s54, 491520
    s_barrier
    buffer_load_dwordx4 v[64:67], v5, s[44:47], s63 offen
    buffer_load_dwordx4 v[92:95], v5, s[48:51], s63 offen
    s_add_u32 s63, s63, 28672
    buffer_load_dwordx4 v[68:71], v5, s[44:47], s63 offen
    buffer_load_dwordx4 v[96:99], v5, s[48:51], s63 offen
    s_add_u32 s63, s63, 28672
    buffer_load_dwordx4 v[72:75], v5, s[44:47], s63 offen
    buffer_load_dwordx4 v[100:103], v5, s[48:51], s63 offen
    s_add_u32 s63, s63, 28672
    buffer_load_dwordx4 v[76:79], v5, s[44:47], s63 offen
    buffer_load_dwordx4 v[104:107], v5, s[48:51], s63 offen
    s_add_u32 s63, s63, 28672
    buffer_load_dwordx4 v[80:83], v5, s[44:47], s63 offen
    buffer_load_dwordx4 v[108:111], v5, s[48:51], s63 offen
    s_add_u32 s63, s63, 28672
    buffer_load_dwordx4 v[84:87], v5, s[44:47], s63 offen
    buffer_load_dwordx4 v[112:115], v5, s[48:51], s63 offen
    s_add_u32 s63, s63, 28672
    buffer_load_dwordx4 v[88:91], v5, s[44:47], s63 offen
    buffer_load_dwordx4 v[116:119], v5, s[48:51], s63 offen
    s_waitcnt vmcnt(14)
    s_load_dword s52, s[32:33], 0
    s_waitcnt lgkmcnt(0)
    s_cmp_eq_u32 s52, 0
    s_cbranch_scc1 L_nonce_36
L_ndone_37:
    s_barrier
    s_cmp_lg_u32 s3, 0
    s_cbranch_scc1 L_nf1_38
    s_lshl_b32 s54, s66, 7
    s_add_u32 s54, s54, 14680064
    v_mov_b32 v14, s52
    v_lshlrev_b32 v15, 19, v1
    s_mov_b64 exec, 15
    buffer_store_dword v14, v15, s[36:39], s54 offen sc1
    s_mov_b64 exec, -1
L_nf1_38:
    v_mov_b32 v176, 0
    v_mov_b32 v177, 0
    v_mov_b32 v178, 0
    v_mov_b32 v179, 0
    v_mov_b32 v180, 0
    v_mov_b32 v181, 0
    v_mov_b32 v182, 0
    v_mov_b32 v183, 0
    v_mov_b32 v184, 0
    v_mov_b32 v185, 0
    v_mov_b32 v186, 0
    v_mov_b32 v187, 0
    v_mov_b32 v188, 0
    v_mov_b32 v189, 0
    v_mov_b32 v190, 0
    v_mov_b32 v191, 0
    s_waitcnt vmcnt(12)
    v_dot2c_f32_bf16 v176, s70, v64
    v_dot2c_f32_bf16 v177, s71, v64
    v_dot2c_f32_bf16 v178, s70, v65
    v_dot2c_f32_bf16 v179, s71, v65
    v_dot2c_f32_bf16 v180, s70, v66
    v_dot2c_f32_bf16 v181, s71, v66
    v_dot2c_f32_bf16 v182, s70, v67
    v_dot2c_f32_bf16 v183, s71, v67
    v_dot2c_f32_bf16 v184, s70, v92
    v_dot2c_f32_bf16 v185, s71, v92
    v_dot2c_f32_bf16 v186, s70, v93
    v_dot2c_f32_bf16 v187, s71, v93
    v_dot2c_f32_bf16 v188, s70, v94
    v_dot2c_f32_bf16 v189, s71, v94
    v_dot2c_f32_bf16 v190, s70, v95
    v_dot2c_f32_bf16 v191, s71, v95
    s_waitcnt vmcnt(10)
    v_dot2c_f32_bf16 v176, s70, v68
    v_dot2c_f32_bf16 v177, s71, v68
    v_dot2c_f32_bf16 v178, s70, v69
    v_dot2c_f32_bf16 v179, s71, v69
    v_dot2c_f32_bf16 v180, s70, v70
    v_dot2c_f32_bf16 v181, s71, v70
    v_dot2c_f32_bf16 v182, s70, v71
    v_dot2c_f32_bf16 v183, s71, v71
    v_dot2c_f32_bf16 v184, s70, v96
    v_dot2c_f32_bf16 v185, s71, v96
    v_dot2c_f32_bf16 v186, s70, v97
    v_dot2c_f32_bf16 v187, s71, v97
    v_dot2c_f32_bf16 v188, s70, v98
    v_dot2c_f32_bf16 v189, s71, v98
    v_dot2c_f32_bf16 v190, s70, v99
    v_dot2c_f32_bf16 v191, s71, v99
    s_waitcnt vmcnt(8)
    v_dot2c_f32_bf16 v176, s70, v72
    v_dot2c_f32_bf16 v177, s71, v72
    v_dot2c_f32_bf16 v178, s70, v73
    v_dot2c_f32_bf16 v179, s71, v73
    v_dot2c_f32_bf16 v180, s70, v74
    v_dot2c_f32_bf16 v181, s71, v74
    v_dot2c_f32_bf16 v182, s70, v75
    v_dot2c_f32_bf16 v183, s71, v75
    v_dot2c_f32_bf16 v184, s70, v100
    v_dot2c_f32_bf16 v185, s71, v100
    v_dot2c_f32_bf16 v186, s70, v101
    v_dot2c_f32_bf16 v187, s71, v101
    v_dot2c_f32_bf16 v188, s70, v102
    v_dot2c_f32_bf16 v189, s71, v102
    v_dot2c_f32_bf16 v190, s70, v103
    v_dot2c_f32_bf16 v191, s71, v103
    s_waitcnt vmcnt(6)
    v_dot2c_f32_bf16 v176, s70, v76
    v_dot2c_f32_bf16 v177, s71, v76
    v_dot2c_f32_bf16 v178, s70, v77
    v_dot2c_f32_bf16 v179, s71, v77
    v_dot2c_f32_bf16 v180, s70, v78
    v_dot2c_f32_bf16 v181, s71, v78
    v_dot2c_f32_bf16 v182, s70, v79
    v_dot2c_f32_bf16 v183, s71, v79
    v_dot2c_f32_bf16 v184, s70, v104
    v_dot2c_f32_bf16 v185, s71, v104
    v_dot2c_f32_bf16 v186, s70, v105
    v_dot2c_f32_bf16 v187, s71, v105
    v_dot2c_f32_bf16 v188, s70, v106
    v_dot2c_f32_bf16 v189, s71, v106
    v_dot2c_f32_bf16 v190, s70, v107
    v_dot2c_f32_bf16 v191, s71, v107
    s_waitcnt vmcnt(4)
    v_dot2c_f32_bf16 v176, s70, v80
    v_dot2c_f32_bf16 v177, s71, v80
    v_dot2c_f32_bf16 v178, s70, v81
    v_dot2c_f32_bf16 v179, s71, v81
    v_dot2c_f32_bf16 v180, s70, v82
    v_dot2c_f32_bf16 v181, s71, v82
    v_dot2c_f32_bf16 v182, s70, v83
    v_dot2c_f32_bf16 v183, s71, v83
    v_dot2c_f32_bf16 v184, s70, v108
    v_dot2c_f32_bf16 v185, s71, v108
    v_dot2c_f32_bf16 v186, s70, v109
    v_dot2c_f32_bf16 v187, s71, v109
    v_dot2c_f32_bf16 v188, s70, v110
    v_dot2c_f32_bf16 v189, s71, v110
    v_dot2c_f32_bf16 v190, s70, v111
    v_dot2c_f32_bf16 v191, s71, v111
    s_waitcnt vmcnt(2)
    v_dot2c_f32_bf16 v176, s70, v84
    v_dot2c_f32_bf16 v177, s71, v84
    v_dot2c_f32_bf16 v178, s70, v85
    v_dot2c_f32_bf16 v179, s71, v85
    v_dot2c_f32_bf16 v180, s70, v86
    v_dot2c_f32_bf16 v181, s71, v86
    v_dot2c_f32_bf16 v182, s70, v87
    v_dot2c_f32_bf16 v183, s71, v87
    v_dot2c_f32_bf16 v184, s70, v112
    v_dot2c_f32_bf16 v185, s71, v112
    v_dot2c_f32_bf16 v186, s70, v113
    v_dot2c_f32_bf16 v187, s71, v113
    v_dot2c_f32_bf16 v188, s70, v114
    v_dot2c_f32_bf16 v189, s71, v114
    v_dot2c_f32_bf16 v190, s70, v115
    v_dot2c_f32_bf16 v191, s71, v115
    s_waitcnt vmcnt(0)
    v_dot2c_f32_bf16 v176, s70, v88
    v_dot2c_f32_bf16 v177, s71, v88
    v_dot2c_f32_bf16 v178, s70, v89
    v_dot2c_f32_bf16 v179, s71, v89
    v_dot2c_f32_bf16 v180, s70, v90
    v_dot2c_f32_bf16 v181, s71, v90
    v_dot2c_f32_bf16 v182, s70, v91
    v_dot2c_f32_bf16 v183, s71, v91
    v_dot2c_f32_bf16 v184, s70, v116
    v_dot2c_f32_bf16 v185, s71, v116
    v_dot2c_f32_bf16 v186, s70, v117
    v_dot2c_f32_bf16 v187, s71, v117
    v_dot2c_f32_bf16 v188, s70, v118
    v_dot2c_f32_bf16 v189, s71, v118
    v_dot2c_f32_bf16 v190, s70, v119
    v_dot2c_f32_bf16 v191, s71, v119
    s_mul_i32 s54, s3, 4176
    s_add_u32 m0, s54, 0
    s_nop 0
    ds_write_addtid_b32 v176 offset:0
    ds_write_addtid_b32 v177 offset:260
    ds_write_addtid_b32 v178 offset:520
    ds_write_addtid_b32 v179 offset:780
    ds_write_addtid_b32 v180 offset:1040
    ds_write_addtid_b32 v181 offset:1300
    ds_write_addtid_b32 v182 offset:1560
    ds_write_addtid_b32 v183 offset:1820
    ds_write_addtid_b32 v184 offset:2080
    ds_write_addtid_b32 v185 offset:2340
    ds_write_addtid_b32 v186 offset:2600
    ds_write_addtid_b32 v187 offset:2860
    ds_write_addtid_b32 v188 offset:3120
    ds_write_addtid_b32 v189 offset:3380
    ds_write_addtid_b32 v190 offset:3640
    ds_write_addtid_b32 v191 offset:3900
    s_waitcnt vmcnt(0)
    v_lshrrev_b32 v6, 2, v0
    v_and_b32 v7, 3, v0
    v_lshrrev_b32 v8, 6, v6
    v_and_b32 v9, 7, v6
    v_lshl_add_u32 v9, v8, 3, v9
    v_mul_u32_u24 v9, 260, v9
    v_bfe_u32 v10, v6, 3, 3
    v_lshl_add_u32 v9, v10, 2, v9
    v_mul_u32_u24 v10, 8352, v7
    v_add_u32 v9, v9, v10
    v_add_u32 v10, 4176, v9
    v_add_u32 v9, 0, v9
    s_waitcnt lgkmcnt(0)
    s_barrier
    ds_read2_b32 v[16:17], v9 offset0:0 offset1:8
    ds_read2_b32 v[18:19], v9 offset0:16 offset1:24
    ds_read2_b32 v[20:21], v9 offset0:32 offset1:40
    ds_read2_b32 v[22:23], v9 offset0:48 offset1:56
    ds_read2_b32 v[24:25], v10 offset0:0 offset1:8
    ds_read2_b32 v[26:27], v10 offset0:16 offset1:24
    ds_read2_b32 v[28:29], v10 offset0:32 offset1:40
    ds_read2_b32 v[30:31], v10 offset0:48 offset1:56
    v_and_b32 v11, 15, v6
    v_lshl_add_u32 v11, v8, 4, v11
    v_bfe_u32 v12, v6, 5, 1
    v_lshl_add_u32 v11, v12, 5, v11
    v_lshlrev_b32 v11, 4, v11
    v_bfe_u32 v12, v6, 4, 1
    v_lshl_add_u32 v11, v12, 3, v11
    s_lshl_b32 s54, s60, 1
    s_add_u32 s54, s54, s68
    s_lshl_b32 s55, s54, 10
    s_add_u32 s55, s55, 65536
    s_waitcnt lgkmcnt(0)
    v_add_f32 v16, v16, v24
    v_add_f32 v17, v17, v25
    v_add_f32 v18, v18, v26
    v_add_f32 v19, v19, v27
    v_add_f32 v20, v20, v28
    v_add_f32 v21, v21, v29
    v_add_f32 v22, v22, v30
    v_add_f32 v23, v23, v31
    v_add_f32 v16, v16, v20
    v_add_f32 v17, v17, v21
    v_add_f32 v18, v18, v22
    v_add_f32 v19, v19, v23
    v_add_f32 v16, v16, v18
    v_add_f32 v17, v17, v19
    v_add_f32 v16, v16, v17
    s_nop 1
    v_add_f32_dpp v17, v16, v16 quad_perm:[1,0,3,2] row_mask:0xf bank_mask:0xf bound_ctrl:1
    s_nop 1
    v_add_f32_dpp v16, v17, v17 quad_perm:[2,3,0,1] row_mask:0xf bank_mask:0xf bound_ctrl:1
    v_cvt_pk_bf16_f32 v17, v16, v16
    v_lshlrev_b32 v17, 16, v17
    v_sub_f32 v17, v16, v17
    v_cvt_pk_bf16_f32 v20, v16, v17
    v_and_b32 v18, 0xffff0000, v20
    v_sub_f32 v18, v17, v18
    v_cvt_pk_bf16_f32 v21, v18, 0
    s_cmp_ge_u32 s67, 14
    s_cbranch_scc1 L_auxend
    s_mov_b32 exec_lo, 0x11111111
    s_mov_b32 exec_hi, 0x11111111
    buffer_store_dwordx2 v[20:21], v11, s[36:39], s55 offen sc1
    s_mov_b64 exec, -1
    s_waitcnt vmcnt(0)
    s_barrier
    s_cmp_lg_u32 s3, 0
    s_cbranch_scc1 L_auxend
    s_lshl_b32 s54, s54, 7
    s_add_u32 s54, s54, 14684160
    v_mov_b32 v12, s52
    v_lshlrev_b32 v13, 19, v1
    s_mov_b64 exec, 15
    buffer_store_dword v12, v13, s[36:39], s54 offen sc1
    s_mov_b64 exec, -1
L_auxend:
L_end:
    s_endpgm
L_nonce_10:
    s_mov_b32 s58, 16384
L_nonce_10_l:
    v_mov_b32 v3, 0
    global_load_dword v3, v3, s[32:33] sc1
    s_sub_u32 s58, s58, 1
    s_waitcnt vmcnt(0)
    v_readfirstlane_b32 s52, v3
    s_cmp_eq_u32 s58, 0
    s_cbranch_scc1 L_ndone_11
    s_cmp_lg_u32 s52, 0
    s_cbranch_scc1 L_ndone_11
    s_sleep 4
    s_branch L_nonce_10_l
L_retry_12:
    s_mov_b32 s58, 3
L_retry_12_s:
    s_sleep 2
    s_add_u32 s22, s22, 524288
    s_addc_u32 s23, s23, 0
    s_load_dword s6, s[22:23], 0
    s_load_dword s7, s[22:23], 256
    s_load_dword s8, s[22:23], 512
    s_load_dword s9, s[22:23], 768
    s_load_dword s10, s[22:23], 1024
    s_load_dword s11, s[22:23], 1280
    s_load_dword s12, s[22:23], 1536
    s_load_dword s13, s[22:23], 1792
    s_load_dword s14, s[22:23], 2048
    s_load_dword s15, s[22:23], 2304
    s_load_dword s16, s[22:23], 2560
    s_load_dword s17, s[22:23], 2816
    s_load_dword s18, s[22:23], 3072
    s_load_dword s19, s[22:23], 3328
    s_waitcnt lgkmcnt(0)
    s_xor_b32 s6, s6, s52
    s_xor_b32 s7, s7, s52
    s_or_b32 s6, s6, s7
    s_xor_b32 s8, s8, s52
    s_or_b32 s6, s6, s8
    s_xor_b32 s9, s9, s52
    s_or_b32 s6, s6, s9
    s_xor_b32 s10, s10, s52
    s_or_b32 s6, s6, s10
    s_xor_b32 s11, s11, s52
    s_or_b32 s6, s6, s11
    s_xor_b32 s12, s12, s52
    s_or_b32 s6, s6, s12
    s_xor_b32 s13, s13, s52
    s_or_b32 s6, s6, s13
    s_xor_b32 s14, s14, s52
    s_or_b32 s6, s6, s14
    s_xor_b32 s15, s15, s52
    s_or_b32 s6, s6, s15
    s_xor_b32 s16, s16, s52
    s_or_b32 s6, s6, s16
    s_xor_b32 s17, s17, s52
    s_or_b32 s6, s6, s17
    s_xor_b32 s18, s18, s52
    s_or_b32 s6, s6, s18
    s_xor_b32 s19, s19, s52
    s_or_b32 s6, s6, s19
    s_cmp_lg_u32 s6, 0
    s_cbranch_scc0 L_seen_13
    s_sub_u32 s58, s58, 1
    s_cmp_lg_u32 s58, 0
    s_cbranch_scc1 L_retry_12_s
    v_min_u32 v12, 13, v1
    v_lshlrev_b32 v12, 8, v12
    s_mov_b32 s58, 16384
L_retry_12_v:
    buffer_load_dword v13, v12, s[36:39], s4 offen sc1
    s_sub_u32 s58, s58, 1
    s_cmp_eq_u32 s58, 0
    s_waitcnt vmcnt(0)
    s_cbranch_scc1 L_seen_13
    v_cmp_ne_u32 vcc, s52, v13
    s_cbranch_vccz L_seen_13
    s_sleep 4
    s_branch L_retry_12_v
L_spin_14:
    s_mov_b32 s58, 262144
L_spin_14_l:
    s_sleep 1
    ds_read_b32 v13, v11
    s_waitcnt lgkmcnt(0)
    v_cmp_gt_u32 vcc, v15, v13
    s_cbranch_vccz L_sdone_15
    s_sub_u32 s58, s58, 1
    s_cmp_lg_u32 s58, 0
    s_cbranch_scc1 L_spin_14_l
    s_branch L_sdone_15
L_retry_16:
    s_mov_b32 s58, 3
L_retry_16_s:
    s_sleep 4
    s_add_u32 s22, s22, 524288
    s_addc_u32 s23, s23, 0
    s_load_dword s6, s[22:23], 0
    s_load_dword s7, s[22:23], 128
    s_load_dword s8, s[22:23], 256
    s_load_dword s9, s[22:23], 384
    s_load_dword s10, s[22:23], 512
    s_load_dword s11, s[22:23], 640
    s_load_dword s12, s[22:23], 768
    s_load_dword s13, s[22:23], 896
    s_waitcnt lgkmcnt(0)
    s_xor_b32 s6, s6, s52
    s_xor_b32 s7, s7, s52
    s_or_b32 s6, s6, s7
    s_xor_b32 s8, s8, s52
    s_or_b32 s6, s6, s8
    s_xor_b32 s9, s9, s52
    s_or_b32 s6, s6, s9
    s_xor_b32 s10, s10, s52
    s_or_b32 s6, s6, s10
    s_xor_b32 s11, s11, s52
    s_or_b32 s6, s6, s11
    s_xor_b32 s12, s12, s52
    s_or_b32 s6, s6, s12
    s_xor_b32 s13, s13, s52
    s_or_b32 s6, s6, s13
    s_cmp_lg_u32 s6, 0
    s_cbranch_scc0 L_seen_17
    s_sub_u32 s58, s58, 1
    s_cmp_lg_u32 s58, 0
    s_cbranch_scc1 L_retry_16_s
    v_min_u32 v12, 7, v1
    v_lshlrev_b32 v12, 7, v12
    s_mov_b32 s58, 16384
L_retry_16_v:
    buffer_load_dword v13, v12, s[36:39], s4 offen sc1
    s_sub_u32 s58, s58, 1
    s_cmp_eq_u32 s58, 0
    s_waitcnt vmcnt(0)
    s_cbranch_scc1 L_seen_17
    v_cmp_ne_u32 vcc, s52, v13
    s_cbranch_vccz L_seen_17
    s_sleep 4
    s_branch L_retry_16_v
L_nonce_18:
    s_mov_b32 s58, 16384
L_nonce_18_l:
    v_mov_b32 v12, 0
    global_load_dword v12, v12, s[32:33] sc1
    s_sub_u32 s58, s58, 1
    s_waitcnt vmcnt(0)
    v_readfirstlane_b32 s52, v12
    s_cmp_eq_u32 s58, 0
    s_cbranch_scc1 L_ndone_19
    s_cmp_lg_u32 s52, 0
    s_cbranch_scc1 L_ndone_19
    s_sleep 4
    s_branch L_nonce_18_l
L_retry_20:
    s_mov_b32 s58, 3
L_retry_20_s:
    s_sleep 4
    s_add_u32 s22, s22, 524288
    s_addc_u32 s23, s23, 0
    s_load_dword s6, s[22:23], 0
    s_load_dword s7, s[22:23], 128
    s_load_dword s8, s[22:23], 256
    s_load_dword s9, s[22:23], 384
    s_load_dword s10, s[22:23], 512
    s_load_dword s11, s[22:23], 640
    s_load_dword s12, s[22:23], 768
    s_load_dword s13, s[22:23], 896
    s_waitcnt lgkmcnt(0)
    s_xor_b32 s6, s6, s52
    s_xor_b32 s7, s7, s52
    s_or_b32 s6, s6, s7
    s_xor_b32 s8, s8, s52
    s_or_b32 s6, s6, s8
    s_xor_b32 s9, s9, s52
    s_or_b32 s6, s6, s9
    s_xor_b32 s10, s10, s52
    s_or_b32 s6, s6, s10
    s_xor_b32 s11, s11, s52
    s_or_b32 s6, s6, s11
    s_xor_b32 s12, s12, s52
    s_or_b32 s6, s6, s12
    s_xor_b32 s13, s13, s52
    s_or_b32 s6, s6, s13
    s_cmp_lg_u32 s6, 0
    s_cbranch_scc0 L_seen_21
    s_sub_u32 s58, s58, 1
    s_cmp_lg_u32 s58, 0
    s_cbranch_scc1 L_retry_20_s
    v_min_u32 v12, 7, v1
    v_lshlrev_b32 v12, 7, v12
    s_mov_b32 s58, 16384
L_retry_20_v:
    buffer_load_dword v13, v12, s[36:39], s4 offen sc1
    s_sub_u32 s58, s58, 1
    s_cmp_eq_u32 s58, 0
    s_waitcnt vmcnt(0)
    s_cbranch_scc1 L_seen_21
    v_cmp_ne_u32 vcc, s52, v13
    s_cbranch_vccz L_seen_21
    s_sleep 4
    s_branch L_retry_20_v
L_retry_22:
    s_mov_b32 s58, 3
L_retry_22_s:
    s_sleep 4
    s_add_u32 s22, s22, 524288
    s_addc_u32 s23, s23, 0
    s_load_dword s6, s[22:23], 0
    s_load_dword s7, s[22:23], 128
    s_waitcnt lgkmcnt(0)
    s_xor_b32 s6, s6, s52
    s_xor_b32 s7, s7, s52
    s_or_b32 s6, s6, s7
    s_cmp_lg_u32 s6, 0
    s_cbranch_scc0 L_seen_23
    s_sub_u32 s58, s58, 1
    s_cmp_lg_u32 s58, 0
    s_cbranch_scc1 L_retry_22_s
    v_min_u32 v12, 1, v1
    v_lshlrev_b32 v12, 7, v12
    s_mov_b32 s58, 16384
L_retry_22_v:
    buffer_load_dword v13, v12, s[36:39], s4 offen sc1
    s_sub_u32 s58, s58, 1
    s_cmp_eq_u32 s58, 0
    s_waitcnt vmcnt(0)
    s_cbranch_scc1 L_seen_23
    v_cmp_ne_u32 vcc, s52, v13
    s_cbranch_vccz L_seen_23
    s_sleep 4
    s_branch L_retry_22_v
L_spin_25:
    s_mov_b32 s58, 262144
L_spin_25_l:
    s_sleep 1
    ds_read_b32 v13, v11
    s_waitcnt lgkmcnt(0)
    v_cmp_gt_u32 vcc, 5, v13
    s_cbranch_vccz L_sdone_26
    s_sub_u32 s58, s58, 1
    s_cmp_lg_u32 s58, 0
    s_cbranch_scc1 L_spin_25_l
    s_branch L_sdone_26
L_spin_27:
    s_mov_b32 s58, 262144
L_spin_27_l:
    s_sleep 1
    ds_read_b32 v13, v11
    s_waitcnt lgkmcnt(0)
    v_cmp_gt_u32 vcc, 6, v13
    s_cbranch_vccz L_sdone_28
    s_sub_u32 s58, s58, 1
    s_cmp_lg_u32 s58, 0
    s_cbranch_scc1 L_spin_27_l
    s_branch L_sdone_28
L_retry_29:
    s_mov_b32 s58, 3
L_retry_29_s:
    s_sleep 2
    s_add_u32 s22, s22, 524288
    s_addc_u32 s23, s23, 0
    s_load_dword s6, s[22:23], 0
    s_load_dword s7, s[22:23], 256
    s_load_dword s8, s[22:23], 512
    s_load_dword s9, s[22:23], 768
    s_load_dword s10, s[22:23], 1024
    s_load_dword s11, s[22:23], 1280
    s_load_dword s12, s[22:23], 1536
    s_load_dword s13, s[22:23], 1792
    s_load_dword s14, s[22:23], 2048
    s_load_dword s15, s[22:23], 2304
    s_load_dword s16, s[22:23], 2560
    s_load_dword s17, s[22:23], 2816
    s_load_dword s18, s[22:23], 3072
    s_load_dword s19, s[22:23], 3328
    s_waitcnt lgkmcnt(0)
    s_xor_b32 s6, s6, s52
    s_xor_b32 s7, s7, s52
    s_or_b32 s6, s6, s7
    s_xor_b32 s8, s8, s52
    s_or_b32 s6, s6, s8
    s_xor_b32 s9, s9, s52
    s_or_b32 s6, s6, s9
    s_xor_b32 s10, s10, s52
    s_or_b32 s6, s6, s10
    s_xor_b32 s11, s11, s52
    s_or_b32 s6, s6, s11
    s_xor_b32 s12, s12, s52
    s_or_b32 s6, s6, s12
    s_xor_b32 s13, s13, s52
    s_or_b32 s6, s6, s13
    s_xor_b32 s14, s14, s52
    s_or_b32 s6, s6, s14
    s_xor_b32 s15, s15, s52
    s_or_b32 s6, s6, s15
    s_xor_b32 s16, s16, s52
    s_or_b32 s6, s6, s16
    s_xor_b32 s17, s17, s52
    s_or_b32 s6, s6, s17
    s_xor_b32 s18, s18, s52
    s_or_b32 s6, s6, s18
    s_xor_b32 s19, s19, s52
    s_or_b32 s6, s6, s19
    s_cmp_lg_u32 s6, 0
    s_cbranch_scc0 L_seen_30
    s_sub_u32 s58, s58, 1
    s_cmp_lg_u32 s58, 0
    s_cbranch_scc1 L_retry_29_s
    v_min_u32 v12, 13, v1
    v_lshlrev_b32 v12, 8, v12
    s_mov_b32 s58, 16384
L_retry_29_v:
    buffer_load_dword v13, v12, s[36:39], s4 offen sc1
    s_sub_u32 s58, s58, 1
    s_cmp_eq_u32 s58, 0
    s_waitcnt vmcnt(0)
    s_cbranch_scc1 L_seen_30
    v_cmp_ne_u32 vcc, s52, v13
    s_cbranch_vccz L_seen_30
    s_sleep 4
    s_branch L_retry_29_v
L_spin_31:
    s_mov_b32 s58, 262144
L_spin_31_l:
    s_sleep 1
    ds_read_b32 v13, v11
    s_waitcnt lgkmcnt(0)
    v_cmp_gt_u32 vcc, v15, v13
    s_cbranch_vccz L_sdone_32
    s_sub_u32 s58, s58, 1
    s_cmp_lg_u32 s58, 0
    s_cbranch_scc1 L_spin_31_l
    s_branch L_sdone_32
L_nonce_36:
    s_mov_b32 s58, 16384
L_nonce_36_l:
    v_mov_b32 v12, 0
    global_load_dword v12, v12, s[32:33] sc1
    s_sub_u32 s58, s58, 1
    s_waitcnt vmcnt(0)
    v_readfirstlane_b32 s52, v12
    s_cmp_eq_u32 s58, 0
    s_cbranch_scc1 L_ndone_37
    s_cmp_lg_u32 s52, 0
    s_cbranch_scc1 L_ndone_37
    s_sleep 4
    s_branch L_nonce_36_l
L_code_end:
    s_endpgm
.section .rodata,"a"
.p2align 6
.amdhsa_kernel parallel_sum__ssm_conv_s4__glu_gated_reglu__prompt_kernel
  .amdhsa_next_free_vgpr 256
  .amdhsa_next_free_sgpr 102
  .amdhsa_accum_offset 256
  .amdhsa_group_segment_fixed_size 0
  .amdhsa_kernarg_size 128
  .amdhsa_user_sgpr_count 2
  .amdhsa_user_sgpr_kernarg_segment_ptr 1
  .amdhsa_system_sgpr_workgroup_id_x 1
  .amdhsa_float_denorm_mode_32 3
.end_amdhsa_kernel
```
